```python
import torch

def _softmax(x, axis=-1):
    return torch.softmax(x, dim=axis)

def _gelu(x):
    return torch.nn.functional.gelu(x, approximate='tanh')

def _silu(x):
    return torch.nn.functional.silu(x)

def _sigmoid(x):
    return torch.sigmoid(x)

def _layernorm(x, axis=-1, eps=1e-05):
    m = x.mean(dim=axis, keepdim=True)
    v = x.var(dim=axis, keepdim=True, unbiased=False)
    return (x - m) / torch.sqrt(v + eps)

def _scatter_add(tgt, idx, src, axis=0):
    return tgt.clone().index_add_(axis, idx, src)

def _segment_sum(src, seg, n):
    out = torch.zeros((n,) + src.shape[1:], dtype=src.dtype)
    return out.index_add_(0, seg, src)

def _pad(x, pw):
    flat = tuple((v for pair in reversed(pw) for v in pair))
    return torch.nn.functional.pad(x, flat)
kernel_name = 'adaLN_cond__softmax_full_mha__swiglu_ffn__prompt'

def setup_inputs():

    _w = lambda a: (lambda t: t.to(torch.bfloat16) if t.is_floating_point() else t)(torch.as_tensor(a))

    def _A_setup():
        B, S, D = (1, 2048, 512)
        return {'x': _w((lambda *s: torch.randn(*s, dtype=torch.bfloat16) * 0.05)(B, S, D)), 'wqkv': _w((lambda *s: torch.randn(*s, dtype=torch.bfloat16) * 0.05)(D, 3 * D)), 'wo': _w((lambda *s: torch.randn(*s, dtype=torch.bfloat16) * 0.05)(D, D))}
    _A_in = _A_setup()

    def _B_setup():
        B, S, D, F = (1, 2048, 512, 1792)
        return {'x': _w((lambda *s: torch.randn(*s, dtype=torch.bfloat16) * 0.05)(B, S, D)), 'w_gate': _w((lambda *s: torch.randn(*s, dtype=torch.bfloat16) * 0.05)(D, F)), 'w_up': _w((lambda *s: torch.randn(*s, dtype=torch.bfloat16) * 0.05)(D, F)), 'w_down': _w((lambda *s: torch.randn(*s, dtype=torch.bfloat16) * 0.05)(F, D))}
    _B_in = _B_setup()
    return {'A_x': _A_in['x'], 'A_wqkv': _A_in['wqkv'], 'A_wo': _A_in['wo'], 'B_x': _B_in['x'], 'B_w_gate': _B_in['w_gate'], 'B_w_up': _B_in['w_up'], 'B_w_down': _B_in['w_down'], 'c': _w((lambda *s: torch.randn(*s, dtype=torch.bfloat16) * 0.1)(1, 512) * 8.0), 'w_mod': _w((lambda *s: torch.randn(*s, dtype=torch.bfloat16) * 0.1)(512, 6 * 512) * 512 ** (-0.5) * 8.0)}

def reference(A_x, A_wqkv, A_wo, B_x, B_w_gate, B_w_up, B_w_down, c, w_mod):

    def _A_ref(x, wqkv, wo):
        B, S, D = x.shape
        H = 32
        Dh = D // H
        qkv = (lambda x, *d: x.permute(*d))((x @ wqkv).reshape(B, S, 3, H, Dh), 2, 0, 3, 1, 4)
        q, k, v = (qkv[0], qkv[1], qkv[2])
        scale = Dh ** (-0.5)
        scores = torch.einsum('bhqd,bhkd->bhqk', q, k) * scale
        p = _softmax(scores, axis=-1)
        o = torch.einsum('bhqk,bhkd->bhqd', p, v)
        return (lambda x, *d: x.permute(*d))(o, 0, 2, 1, 3).reshape(B, S, D) @ wo

    def _B_ref(x, w_gate, w_up, w_down):
        g = _silu(x @ w_gate)
        u = x @ w_up
        return g * u @ w_down
    x = A_x
    mod = (_silu(c) @ w_mod).reshape(c.shape[0], 6, 1, -1)
    sa, ca, ga, sb, cb, gb = (mod[:, 0].clone(), mod[:, 1].clone(), mod[:, 2].clone(), mod[:, 3].clone(), mod[:, 4].clone(), mod[:, 5].clone())
    h = _layernorm(x, axis=-1) * (1 + ca) + sa
    x = x + ga * _A_ref(h, A_wqkv, A_wo)
    h = _layernorm(x, axis=-1) * (1 + cb) + sb
    x = x + gb * _B_ref(h, B_w_gate, B_w_up, B_w_down)
    return x
```

```asm
; @launch grid=(256,1,1) block=(768,1,1) lds=163840
.amdgcn_target "amdgcn-amd-amdhsa--gfx950"
.text
.globl adaLN_cond__softmax_full_mha__swiglu_ffn__prompt_kernel
.p2align 8
.type adaLN_cond__softmax_full_mha__swiglu_ffn__prompt_kernel,@function
adaLN_cond__softmax_full_mha__swiglu_ffn__prompt_kernel:
    v_lshrrev_b32 v2, 6, v0
    s_load_dwordx2 s[96:97], s[0:1], 64
    s_load_dwordx2 s[28:29], s[0:1], 0
    s_load_dwordx2 s[32:33], s[0:1], 8
    s_load_dwordx2 s[14:15], s[0:1], 56
    s_load_dwordx2 s[64:65], s[0:1], 80
    v_readfirstlane_b32 s60, v2
    s_cmp_ge_u32 s2, 256
    s_cbranch_scc1 KB_EXIT
    s_sub_u32 s3, s2, 64
    s_cmp_lt_u32 s3, 48
    s_cbranch_scc0 KB_NOCT
    v_cmp_gt_u32 vcc, 64, v0
    s_cbranch_vccz KB_NOCT
    s_getpc_b64 s[8:9]
KB_PC:
    s_lshr_b32 s3, s3, 3
    s_lshl_b32 s3, s3, 13
    v_lshl_add_u32 v2, v0, 7, s3
    v_min_u32 v2, CODE_END-KB_PC-4, v2
    global_load_dword v159, v2, s[8:9]
KB_NOCT:
    v_and_b32 v1, 63, v0
    s_load_dwordx2 s[52:53], s[0:1], 88
    s_load_dwordx2 s[36:37], s[0:1], 16
    s_load_dwordx2 s[40:41], s[0:1], 32
    s_load_dwordx2 s[44:45], s[0:1], 40
    s_load_dwordx2 s[48:49], s[0:1], 48
    s_load_dwordx2 s[56:57], s[0:1], 72
    s_mov_b32 s98, 0x300000
    s_mov_b32 s99, 0x00020000
    s_mov_b32 s30, 0x200000
    s_mov_b32 s31, 0x00020000
    s_mov_b32 s34, 0x180000
    s_mov_b32 s35, 0x00020000
    s_cmp_lt_u32 s60, 8
    s_cbranch_scc1 P2_COMP
    s_cmp_gt_u32 s60, 9
    s_cbranch_scc1 P2_X
    s_setprio 3
    s_cmp_eq_u32 s60, 9
    s_cbranch_scc1 P2_E9
    s_cmp_ge_u32 s2, 64
    s_cbranch_scc1 P2_GT
    s_memrealtime s[12:13]
    s_and_b32 s16, s2, 7
    s_lshl_b32 s16, s16, 3
    s_bfe_u32 s17, s2, 0x30003
    s_add_u32 s16, s16, s17
    s_lshl_b32 s17, s16, 5
    v_lshlrev_b32 v20, 4, v1
    v_lshrrev_b32 v4, 1, v1
    v_mul_u32_u24 v4, 6144, v4
    v_and_b32 v10, 1, v1
    v_lshl_add_u32 v4, v10, 4, v4
    v_add_u32 v5, 195584, v4
    v_add_u32 v6, 391168, v4
    v_add_u32 v7, 586752, v4
    s_mov_b32 m0, 139264
    s_waitcnt lgkmcnt(0)
    s_and_b32 s97, s97, 0xffff
    buffer_load_dwordx4 v4, s[96:99], s17 offen offset:0  lds
    buffer_load_dwordx4 v5, s[96:99], s17 offen offset:1024  lds
    buffer_load_dwordx4 v6, s[96:99], s17 offen offset:2048  lds
    buffer_load_dwordx4 v7, s[96:99], s17 offen offset:3072  lds
    global_load_dwordx4 v[96:99], v20, s[14:15]
    s_mov_b32 m0, 143360
    s_add_u32 s17, s17, 786432
    buffer_load_dwordx4 v4, s[96:99], s17 offen offset:0  lds
    buffer_load_dwordx4 v5, s[96:99], s17 offen offset:1024  lds
    buffer_load_dwordx4 v6, s[96:99], s17 offen offset:2048  lds
    buffer_load_dwordx4 v7, s[96:99], s17 offen offset:3072  lds
    s_mov_b32 m0, 147456
    s_add_u32 s17, s17, 786432
    buffer_load_dwordx4 v4, s[96:99], s17 offen offset:0  lds
    buffer_load_dwordx4 v5, s[96:99], s17 offen offset:1024  lds
    buffer_load_dwordx4 v6, s[96:99], s17 offen offset:2048  lds
    buffer_load_dwordx4 v7, s[96:99], s17 offen offset:3072  lds
    s_mov_b32 m0, 151552
    s_add_u32 s17, s17, 786432
    buffer_load_dwordx4 v4, s[96:99], s17 offen offset:0  lds
    buffer_load_dwordx4 v5, s[96:99], s17 offen offset:1024  lds
    buffer_load_dwordx4 v6, s[96:99], s17 offen offset:2048  lds
    buffer_load_dwordx4 v7, s[96:99], s17 offen offset:3072  lds
    s_barrier
    s_branch P2_MOD
P2_E9:
    s_memrealtime s[8:9]
    v_lshrrev_b32 v4, 1, v1
    v_mul_u32_u24 v4, 6144, v4
    v_and_b32 v5, 1, v1
    v_lshl_add_u32 v4, v5, 7, v4
    s_lshr_b32 s22, s2, 3
    s_mul_i32 s20, s22, 16*6144
    s_and_b32 s21, s2, 7
    s_lshl_b32 s21, s21, 8
    s_add_u32 s20, s20, s21
    v_lshrrev_b32 v5, 2, v1
    v_lshlrev_b32 v5, 10, v5
    v_and_b32 v6, 3, v1
    v_lshl_add_u32 v5, v6, 7, v5
    s_mul_i32 s22, s22, 24*1024
    s_and_b32 s21, s2, 1
    s_lshl_b32 s21, s21, 9
    s_add_u32 s22, s22, s21
    s_sub_u32 s22, s22, 8*24*1024
    s_add_u32 s23, s22, 16384
    v_lshlrev_b32 v6, 7, v1
    s_bfe_u32 s24, s2, 0x20001
    s_lshl_b32 s24, s24, 19
    s_bfe_u32 s21, s2, 0x40003
    s_lshl_b32 s21, s21, 13
    s_add_u32 s24, s24, s21
    s_mov_b32 exec_hi, 0
    s_waitcnt lgkmcnt(0)
    s_and_b32 s97, s97, 0xffff
    s_and_b32 s29, s29, 0xffff
    s_and_b32 s33, s33, 0xffff
    buffer_load_dword v30, v4, s[96:99], s20 offen
    s_cmp_lt_u32 s2, 64
    s_cbranch_scc1 P2_NOH3
    buffer_load_dword v31, v5, s[32:35], s23 offen
    s_mov_b64 exec, -1
    buffer_load_dword v32, v5, s[32:35], s22 offen
    s_cmp_lt_u32 s2, 128
    s_cbranch_scc1 P2_NOH3
    buffer_load_dword v33, v6, s[28:31], s24 offen
P2_NOH3:
    s_cmp_eq_u32 s2, 0
    s_cbranch_scc0 P2_NONONCE
    s_mov_b32 s4, s64
    s_and_b32 s5, s65, 0xffff
    s_mov_b32 s6, 0x100
    s_mov_b32 s7, 0x00020000
    s_or_b32 s9, s9, 0x40000000
    v_mov_b32 v8, s8
    v_mov_b32 v9, s9
    s_mov_b64 exec, 1
    buffer_store_dwordx2 v[8:9], v6, s[4:7], 0 offen sc1
P2_NONONCE:
    s_mov_b64 exec, -1
P2_NOMOD:
    s_barrier
    s_branch P2_LOADER
P2_GT:
    s_cmp_ge_u32 s2, 72
    s_cbranch_scc1 P2_NOMOD
    v_lshlrev_b32 v4, 7, v1
    s_and_b32 s20, s2, 7
    s_lshl_b32 s20, s20, 13
    s_add_u32 s20, s20, 327680
    s_mov_b32 s54, 0x1980000
    s_mov_b32 s55, 0x00020000
    s_waitcnt lgkmcnt(0)
    s_and_b32 s53, s53, 0xffff
    buffer_load_dword v30, v4, s[52:55], s20 offen sc1
    s_branch P2_NONONCE
P2_COMP:
    s_and_b32 s25, s2, 1
    s_lshl_b32 s25, s25, 2
    s_bfe_u32 s26, s2, 0x20003
    s_add_u32 s25, s25, s26
    s_bfe_u32 s26, s2, 0x20001
    s_lshl_b32 s26, s26, 3
    s_lshr_b32 s27, s2, 5
    s_add_u32 s26, s26, s27
    v_lshlrev_b32 v42, 4, v1
    s_lshl_b32 s27, s26, 16
    s_mov_b32 s21, s60
    s_lshl_b32 s20, s21, 13
    s_add_u32 s27, s27, s20
    s_add_u32 s20, s27, 4096
    v_mov_b32 v49, 159744
    v_mov_b32 v50, 0
    ds_write_b32 v49, v50
    ds_write_b32 v49, v50 offset:4
    s_setprio 1
    s_waitcnt lgkmcnt(0)
    s_and_b32 s29, s29, 0xffff
    s_barrier
    buffer_load_dwordx4 v[8:11], v42, s[28:31], s27 offen offset:0
    buffer_load_dwordx4 v[12:15], v42, s[28:31], s27 offen offset:1024
    buffer_load_dwordx4 v[16:19], v42, s[28:31], s27 offen offset:2048
    buffer_load_dwordx4 v[20:23], v42, s[28:31], s27 offen offset:3072
    buffer_load_dwordx4 v[24:27], v42, s[28:31], s20 offen offset:0
    buffer_load_dwordx4 v[28:31], v42, s[28:31], s20 offen offset:1024
    buffer_load_dwordx4 v[32:35], v42, s[28:31], s20 offen offset:2048
    buffer_load_dwordx4 v[36:39], v42, s[28:31], s20 offen offset:3072
    v_mov_b32 v50, 1
    s_mov_b64 exec, 1
    ds_add_u32 v49, v50 offset:4
    s_mov_b64 exec, -1
    s_and_b32 s97, s97, 0xffff
    s_and_b32 s33, s33, 0xffff
    s_and_b32 s53, s53, 0xffff
    s_mov_b32 s54, 0x1980000
    s_mov_b32 s55, 0x00020000
    s_and_b32 s37, s37, 0xffff
    s_mov_b32 s38, 0x80000
    s_mov_b32 s39, 0x00020000
    s_and_b32 s41, s41, 0xffff
    s_mov_b32 s42, 0x1c0000
    s_mov_b32 s43, 0x00020000
    s_and_b32 s45, s45, 0xffff
    s_mov_b32 s46, 0x1c0000
    s_mov_b32 s47, 0x00020000
    s_and_b32 s49, s49, 0xffff
    s_mov_b32 s50, 0x1c0000
    s_mov_b32 s51, 0x00020000
    s_and_b32 s57, s57, 0xffff
    s_mov_b32 s58, 0x200000
    s_mov_b32 s59, 0x00020000
    v_lshrrev_b32 v54, 3, v1
    v_lshlrev_b32 v43, 13, v54
    v_and_b32 v55, 7, v1
    s_and_b32 s23, s60, 1
    s_lshl_b32 s22, s23, 2
    v_xor_b32 v55, s22, v55
    v_lshl_add_u32 v43, v55, 4, v43
    s_lshl_b32 s22, s21, 10
    v_add_u32 v43, s22, v43
    v_xor_b32 v44, 16, v43
    v_xor_b32 v45, 32, v43
    v_xor_b32 v46, 48, v43
    v_and_b32 v54, 15, v1
    v_lshrrev_b32 v55, 4, v1
    v_bfe_u32 v56, v54, 1, 3
    v_xor_b32 v56, v56, v55
    v_lshlrev_b32 v40, 7, v54
    v_lshl_add_u32 v40, v56, 4, v40
    v_xor_b32 v41, 64, v40
    v_bfe_u32 v56, v1, 2, 2
    v_lshl_add_u32 v56, v55, 3, v56
    v_mul_u32_u24 v47, 384, v56
    v_bfe_u32 v57, v1, 3, 2
    s_and_b32 s24, s60, 3
    v_xor_b32 v57, s24, v57
    v_lshl_add_u32 v47, v57, 5, v47
    v_and_b32 v58, 3, v1
    v_lshl_add_u32 v47, v58, 3, v47
    v_add_u32 v47, 65536, v47
    v_add_u32 v48, 49152, v47
    s_mov_b32 s21, 0x3f803f80
    s_waitcnt vmcnt(7)
    v_dot2_f32_bf16 v144, v8, s21, 0
    v_dot2_f32_bf16 v145, v8, v8, 0
    v_dot2_f32_bf16 v144, v9, s21, v144
    v_dot2_f32_bf16 v145, v9, v9, v145
    v_dot2_f32_bf16 v144, v10, s21, v144
    v_dot2_f32_bf16 v145, v10, v10, v145
    v_dot2_f32_bf16 v144, v11, s21, v144
    v_dot2_f32_bf16 v145, v11, v11, v145
    v_lshlrev_b32 v80, 16, v8
    v_and_b32 v81, 0xffff0000, v8
    v_lshlrev_b32 v82, 16, v9
    v_and_b32 v83, 0xffff0000, v9
    v_lshlrev_b32 v84, 16, v10
    v_and_b32 v85, 0xffff0000, v10
    v_lshlrev_b32 v86, 16, v11
    v_and_b32 v87, 0xffff0000, v11
    s_waitcnt vmcnt(6)
    v_dot2_f32_bf16 v146, v12, s21, 0
    v_dot2_f32_bf16 v147, v12, v12, 0
    v_dot2_f32_bf16 v146, v13, s21, v146
    v_dot2_f32_bf16 v147, v13, v13, v147
    v_dot2_f32_bf16 v146, v14, s21, v146
    v_dot2_f32_bf16 v147, v14, v14, v147
    v_dot2_f32_bf16 v146, v15, s21, v146
    v_dot2_f32_bf16 v147, v15, v15, v147
    v_lshlrev_b32 v88, 16, v12
    v_and_b32 v89, 0xffff0000, v12
    v_lshlrev_b32 v90, 16, v13
    v_and_b32 v91, 0xffff0000, v13
    v_lshlrev_b32 v92, 16, v14
    v_and_b32 v93, 0xffff0000, v14
    v_lshlrev_b32 v94, 16, v15
    v_and_b32 v95, 0xffff0000, v15
    s_waitcnt vmcnt(5)
    v_dot2_f32_bf16 v148, v16, s21, 0
    v_dot2_f32_bf16 v149, v16, v16, 0
    v_dot2_f32_bf16 v148, v17, s21, v148
    v_dot2_f32_bf16 v149, v17, v17, v149
    v_dot2_f32_bf16 v148, v18, s21, v148
    v_dot2_f32_bf16 v149, v18, v18, v149
    v_dot2_f32_bf16 v148, v19, s21, v148
    v_dot2_f32_bf16 v149, v19, v19, v149
    v_lshlrev_b32 v96, 16, v16
    v_and_b32 v97, 0xffff0000, v16
    v_lshlrev_b32 v98, 16, v17
    v_and_b32 v99, 0xffff0000, v17
    v_lshlrev_b32 v100, 16, v18
    v_and_b32 v101, 0xffff0000, v18
    v_lshlrev_b32 v102, 16, v19
    v_and_b32 v103, 0xffff0000, v19
    s_waitcnt vmcnt(4)
    v_dot2_f32_bf16 v150, v20, s21, 0
    v_dot2_f32_bf16 v151, v20, v20, 0
    v_dot2_f32_bf16 v150, v21, s21, v150
    v_dot2_f32_bf16 v151, v21, v21, v151
    v_dot2_f32_bf16 v150, v22, s21, v150
    v_dot2_f32_bf16 v151, v22, v22, v151
    v_dot2_f32_bf16 v150, v23, s21, v150
    v_dot2_f32_bf16 v151, v23, v23, v151
    v_lshlrev_b32 v104, 16, v20
    v_and_b32 v105, 0xffff0000, v20
    v_lshlrev_b32 v106, 16, v21
    v_and_b32 v107, 0xffff0000, v21
    v_lshlrev_b32 v108, 16, v22
    v_and_b32 v109, 0xffff0000, v22
    v_lshlrev_b32 v110, 16, v23
    v_and_b32 v111, 0xffff0000, v23
    s_waitcnt vmcnt(3)
    v_dot2_f32_bf16 v152, v24, s21, 0
    v_dot2_f32_bf16 v153, v24, v24, 0
    v_dot2_f32_bf16 v152, v25, s21, v152
    v_dot2_f32_bf16 v153, v25, v25, v153
    v_dot2_f32_bf16 v152, v26, s21, v152
    v_dot2_f32_bf16 v153, v26, v26, v153
    v_dot2_f32_bf16 v152, v27, s21, v152
    v_dot2_f32_bf16 v153, v27, v27, v153
    v_lshlrev_b32 v112, 16, v24
    v_and_b32 v113, 0xffff0000, v24
    v_lshlrev_b32 v114, 16, v25
    v_and_b32 v115, 0xffff0000, v25
    v_lshlrev_b32 v116, 16, v26
    v_and_b32 v117, 0xffff0000, v26
    v_lshlrev_b32 v118, 16, v27
    v_and_b32 v119, 0xffff0000, v27
    s_waitcnt vmcnt(2)
    v_dot2_f32_bf16 v154, v28, s21, 0
    v_dot2_f32_bf16 v155, v28, v28, 0
    v_dot2_f32_bf16 v154, v29, s21, v154
    v_dot2_f32_bf16 v155, v29, v29, v155
    v_dot2_f32_bf16 v154, v30, s21, v154
    v_dot2_f32_bf16 v155, v30, v30, v155
    v_dot2_f32_bf16 v154, v31, s21, v154
    v_dot2_f32_bf16 v155, v31, v31, v155
    v_lshlrev_b32 v120, 16, v28
    v_and_b32 v121, 0xffff0000, v28
    v_lshlrev_b32 v122, 16, v29
    v_and_b32 v123, 0xffff0000, v29
    v_lshlrev_b32 v124, 16, v30
    v_and_b32 v125, 0xffff0000, v30
    v_lshlrev_b32 v126, 16, v31
    v_and_b32 v127, 0xffff0000, v31
    s_waitcnt vmcnt(1)
    v_dot2_f32_bf16 v156, v32, s21, 0
    v_dot2_f32_bf16 v157, v32, v32, 0
    v_dot2_f32_bf16 v156, v33, s21, v156
    v_dot2_f32_bf16 v157, v33, v33, v157
    v_dot2_f32_bf16 v156, v34, s21, v156
    v_dot2_f32_bf16 v157, v34, v34, v157
    v_dot2_f32_bf16 v156, v35, s21, v156
    v_dot2_f32_bf16 v157, v35, v35, v157
    v_lshlrev_b32 v128, 16, v32
    v_and_b32 v129, 0xffff0000, v32
    v_lshlrev_b32 v130, 16, v33
    v_and_b32 v131, 0xffff0000, v33
    v_lshlrev_b32 v132, 16, v34
    v_and_b32 v133, 0xffff0000, v34
    v_lshlrev_b32 v134, 16, v35
    v_and_b32 v135, 0xffff0000, v35
    s_waitcnt vmcnt(0)
    v_dot2_f32_bf16 v158, v36, s21, 0
    v_dot2_f32_bf16 v159, v36, v36, 0
    v_dot2_f32_bf16 v158, v37, s21, v158
    v_dot2_f32_bf16 v159, v37, v37, v159
    v_dot2_f32_bf16 v158, v38, s21, v158
    v_dot2_f32_bf16 v159, v38, v38, v159
    v_dot2_f32_bf16 v158, v39, s21, v158
    v_dot2_f32_bf16 v159, v39, v39, v159
    v_lshlrev_b32 v136, 16, v36
    v_and_b32 v137, 0xffff0000, v36
    v_lshlrev_b32 v138, 16, v37
    v_and_b32 v139, 0xffff0000, v37
    v_lshlrev_b32 v140, 16, v38
    v_and_b32 v141, 0xffff0000, v38
    v_lshlrev_b32 v142, 16, v39
    v_and_b32 v143, 0xffff0000, v39
    v_permlane32_swap_b32 v144, v152
    v_permlane32_swap_b32 v145, v153
    v_permlane32_swap_b32 v146, v154
    v_permlane32_swap_b32 v147, v155
    v_permlane32_swap_b32 v148, v156
    v_permlane32_swap_b32 v149, v157
    v_permlane32_swap_b32 v150, v158
    v_permlane32_swap_b32 v151, v159
    v_pk_add_f32 v[144:145], v[144:145], v[152:153]
    v_pk_add_f32 v[146:147], v[146:147], v[154:155]
    v_pk_add_f32 v[148:149], v[148:149], v[156:157]
    v_pk_add_f32 v[150:151], v[150:151], v[158:159]
    s_nop 0
    v_permlane16_swap_b32 v144, v148
    v_permlane16_swap_b32 v145, v149
    v_permlane16_swap_b32 v146, v150
    v_permlane16_swap_b32 v147, v151
    v_pk_add_f32 v[144:145], v[144:145], v[148:149]
    v_pk_add_f32 v[146:147], v[146:147], v[150:151]
    s_nop 0
    v_add_f32_dpp v144, v144, v144 row_ror:8 row_mask:0xf bank_mask:0xf
    v_add_f32_dpp v145, v145, v145 row_ror:8 row_mask:0xf bank_mask:0xf
    v_add_f32_dpp v146, v146, v146 row_ror:8 row_mask:0xf bank_mask:0xf
    v_add_f32_dpp v147, v147, v147 row_ror:8 row_mask:0xf bank_mask:0xf
    v_add_f32_dpp v144, v144, v144 row_ror:4 row_mask:0xf bank_mask:0xf
    v_add_f32_dpp v145, v145, v145 row_ror:4 row_mask:0xf bank_mask:0xf
    v_add_f32_dpp v146, v146, v146 row_ror:4 row_mask:0xf bank_mask:0xf
    v_add_f32_dpp v147, v147, v147 row_ror:4 row_mask:0xf bank_mask:0xf
    v_add_f32_dpp v144, v144, v144 row_ror:2 row_mask:0xf bank_mask:0xf
    v_add_f32_dpp v145, v145, v145 row_ror:2 row_mask:0xf bank_mask:0xf
    v_add_f32_dpp v146, v146, v146 row_ror:2 row_mask:0xf bank_mask:0xf
    v_add_f32_dpp v147, v147, v147 row_ror:2 row_mask:0xf bank_mask:0xf
    v_add_f32_dpp v144, v144, v144 row_ror:1 row_mask:0xf bank_mask:0xf
    v_add_f32_dpp v145, v145, v145 row_ror:1 row_mask:0xf bank_mask:0xf
    v_add_f32_dpp v146, v146, v146 row_ror:1 row_mask:0xf bank_mask:0xf
    v_add_f32_dpp v147, v147, v147 row_ror:1 row_mask:0xf bank_mask:0xf
    v_mul_f32 v154, 0x3b000000, v144
    v_fma_f32 v145, -v144, v154, v145
    v_max_f32 v145, 0, v145
    v_mul_f32 v155, 0x3b000000, v146
    v_fma_f32 v147, -v146, v155, v147
    v_max_f32 v147, 0, v147
    v_mul_f32 v145, 0x3b000000, v145
    v_mul_f32 v147, 0x3b000000, v147
    v_cvt_pk_bf16_f32 v145, v145, v154
    v_cvt_pk_bf16_f32 v147, v147, v155
    v_and_b32 v154, 0xffff0000, v145
    v_lshlrev_b32 v145, 16, v145
    v_and_b32 v155, 0xffff0000, v147
    v_lshlrev_b32 v147, 16, v147
    v_add_f32 v145, 0x3727c5ac, v145
    v_add_f32 v147, 0x3727c5ac, v147
    v_cvt_pk_bf16_f32 v145, v145, v145
    v_lshlrev_b32 v145, 16, v145
    v_cvt_pk_bf16_f32 v147, v147, v147
    v_lshlrev_b32 v147, 16, v147
    v_sqrt_f32 v145, v145
    v_sqrt_f32 v147, v147
    v_cvt_pk_bf16_f32 v145, v145, v145
    v_lshlrev_b32 v145, 16, v145
    v_cvt_pk_bf16_f32 v147, v147, v147
    v_lshlrev_b32 v147, 16, v147
    v_rcp_f32 v156, v145
    v_rcp_f32 v158, v147
    v_mul_f32_e64 v157, -v154, v156
    v_mul_f32_e64 v159, -v155, v158
    v_readlane_b32 s4, v156, 0
    v_readlane_b32 s5, v157, 0
    v_readlane_b32 s6, v158, 0
    v_readlane_b32 s7, v159, 0
    v_readlane_b32 s8, v156, 16
    v_readlane_b32 s9, v157, 16
    v_readlane_b32 s10, v158, 16
    v_readlane_b32 s11, v159, 16
    v_readlane_b32 s12, v156, 32
    v_readlane_b32 s13, v157, 32
    v_readlane_b32 s14, v158, 32
    v_readlane_b32 s15, v159, 32
    v_readlane_b32 s16, v156, 48
    v_readlane_b32 s17, v157, 48
    v_readlane_b32 s18, v158, 48
    v_readlane_b32 s19, v159, 48
    v_pk_fma_f32 v[80:81], v[80:81], s[4:5], s[4:5] op_sel:[0,0,1] op_sel_hi:[1,0,1]
    v_pk_fma_f32 v[82:83], v[82:83], s[4:5], s[4:5] op_sel:[0,0,1] op_sel_hi:[1,0,1]
    v_pk_fma_f32 v[84:85], v[84:85], s[4:5], s[4:5] op_sel:[0,0,1] op_sel_hi:[1,0,1]
    v_pk_fma_f32 v[86:87], v[86:87], s[4:5], s[4:5] op_sel:[0,0,1] op_sel_hi:[1,0,1]
    v_pk_fma_f32 v[88:89], v[88:89], s[6:7], s[6:7] op_sel:[0,0,1] op_sel_hi:[1,0,1]
    v_pk_fma_f32 v[90:91], v[90:91], s[6:7], s[6:7] op_sel:[0,0,1] op_sel_hi:[1,0,1]
    v_pk_fma_f32 v[92:93], v[92:93], s[6:7], s[6:7] op_sel:[0,0,1] op_sel_hi:[1,0,1]
    v_pk_fma_f32 v[94:95], v[94:95], s[6:7], s[6:7] op_sel:[0,0,1] op_sel_hi:[1,0,1]
    v_pk_fma_f32 v[96:97], v[96:97], s[8:9], s[8:9] op_sel:[0,0,1] op_sel_hi:[1,0,1]
    v_pk_fma_f32 v[98:99], v[98:99], s[8:9], s[8:9] op_sel:[0,0,1] op_sel_hi:[1,0,1]
    v_pk_fma_f32 v[100:101], v[100:101], s[8:9], s[8:9] op_sel:[0,0,1] op_sel_hi:[1,0,1]
    v_pk_fma_f32 v[102:103], v[102:103], s[8:9], s[8:9] op_sel:[0,0,1] op_sel_hi:[1,0,1]
    v_pk_fma_f32 v[104:105], v[104:105], s[10:11], s[10:11] op_sel:[0,0,1] op_sel_hi:[1,0,1]
    v_pk_fma_f32 v[106:107], v[106:107], s[10:11], s[10:11] op_sel:[0,0,1] op_sel_hi:[1,0,1]
    v_pk_fma_f32 v[108:109], v[108:109], s[10:11], s[10:11] op_sel:[0,0,1] op_sel_hi:[1,0,1]
    v_pk_fma_f32 v[110:111], v[110:111], s[10:11], s[10:11] op_sel:[0,0,1] op_sel_hi:[1,0,1]
    v_pk_fma_f32 v[112:113], v[112:113], s[12:13], s[12:13] op_sel:[0,0,1] op_sel_hi:[1,0,1]
    v_pk_fma_f32 v[114:115], v[114:115], s[12:13], s[12:13] op_sel:[0,0,1] op_sel_hi:[1,0,1]
    v_pk_fma_f32 v[116:117], v[116:117], s[12:13], s[12:13] op_sel:[0,0,1] op_sel_hi:[1,0,1]
    v_pk_fma_f32 v[118:119], v[118:119], s[12:13], s[12:13] op_sel:[0,0,1] op_sel_hi:[1,0,1]
    v_pk_fma_f32 v[120:121], v[120:121], s[14:15], s[14:15] op_sel:[0,0,1] op_sel_hi:[1,0,1]
    v_pk_fma_f32 v[122:123], v[122:123], s[14:15], s[14:15] op_sel:[0,0,1] op_sel_hi:[1,0,1]
    v_pk_fma_f32 v[124:125], v[124:125], s[14:15], s[14:15] op_sel:[0,0,1] op_sel_hi:[1,0,1]
    v_pk_fma_f32 v[126:127], v[126:127], s[14:15], s[14:15] op_sel:[0,0,1] op_sel_hi:[1,0,1]
    v_pk_fma_f32 v[128:129], v[128:129], s[16:17], s[16:17] op_sel:[0,0,1] op_sel_hi:[1,0,1]
    v_pk_fma_f32 v[130:131], v[130:131], s[16:17], s[16:17] op_sel:[0,0,1] op_sel_hi:[1,0,1]
    v_pk_fma_f32 v[132:133], v[132:133], s[16:17], s[16:17] op_sel:[0,0,1] op_sel_hi:[1,0,1]
    v_pk_fma_f32 v[134:135], v[134:135], s[16:17], s[16:17] op_sel:[0,0,1] op_sel_hi:[1,0,1]
    v_pk_fma_f32 v[136:137], v[136:137], s[18:19], s[18:19] op_sel:[0,0,1] op_sel_hi:[1,0,1]
    v_pk_fma_f32 v[138:139], v[138:139], s[18:19], s[18:19] op_sel:[0,0,1] op_sel_hi:[1,0,1]
    v_pk_fma_f32 v[140:141], v[140:141], s[18:19], s[18:19] op_sel:[0,0,1] op_sel_hi:[1,0,1]
    v_pk_fma_f32 v[142:143], v[142:143], s[18:19], s[18:19] op_sel:[0,0,1] op_sel_hi:[1,0,1]
    s_lshl_b32 s20, s25, 2
    s_add_u32 s20, s20, s24
    s_lshl_b32 s20, s20, 16
    s_lshl_b32 s21, s26, 11
    s_add_u32 s20, s20, s21
    s_add_u32 s4, s20, 1048576
    s_add_u32 s5, s20, 3145728
    s_add_u32 s6, s20, 5242880
    s_mov_b32 s8, 0x3eb8aa3b
    v_add_u32 v50, 157696, v42
    s_mov_b32 s95, 0x400000
P2_ABW:
    ds_read_b32 v32, v49
    ds_read_b128 v[24:27], v50
    ds_read_b128 v[28:31], v50 offset:1024
    s_sub_u32 s95, s95, 1
    s_cbranch_scc1 P2_ABOK
    s_waitcnt lgkmcnt(2)
    v_cmp_eq_u32 vcc, 1, v32
    s_cbranch_vccnz P2_ABOK
    s_sleep 1
    s_branch P2_ABW
P2_ABOK:
    s_waitcnt lgkmcnt(0)
    v_lshlrev_b32 v52, 16, v24
    v_and_b32 v53, 0xffff0000, v24
    v_lshlrev_b32 v54, 16, v25
    v_and_b32 v55, 0xffff0000, v25
    v_lshlrev_b32 v56, 16, v26
    v_and_b32 v57, 0xffff0000, v26
    v_lshlrev_b32 v58, 16, v27
    v_and_b32 v59, 0xffff0000, v27
    v_lshlrev_b32 v60, 16, v28
    v_and_b32 v61, 0xffff0000, v28
    v_lshlrev_b32 v62, 16, v29
    v_and_b32 v63, 0xffff0000, v29
    v_lshlrev_b32 v64, 16, v30
    v_and_b32 v65, 0xffff0000, v30
    v_lshlrev_b32 v66, 16, v31
    v_and_b32 v67, 0xffff0000, v31
    v_pk_fma_f32 v[80:81], v[80:81], v[52:53], v[60:61]
    v_pk_fma_f32 v[82:83], v[82:83], v[54:55], v[62:63]
    v_pk_fma_f32 v[84:85], v[84:85], v[56:57], v[64:65]
    v_pk_fma_f32 v[86:87], v[86:87], v[58:59], v[66:67]
    v_cvt_pk_bf16_f32 v8, v80, v81
    v_cvt_pk_bf16_f32 v9, v82, v83
    v_cvt_pk_bf16_f32 v10, v84, v85
    v_cvt_pk_bf16_f32 v11, v86, v87
    ds_write_b128 v43, v[8:11] offset:0
    v_pk_fma_f32 v[88:89], v[88:89], v[52:53], v[60:61]
    v_pk_fma_f32 v[90:91], v[90:91], v[54:55], v[62:63]
    v_pk_fma_f32 v[92:93], v[92:93], v[56:57], v[64:65]
    v_pk_fma_f32 v[94:95], v[94:95], v[58:59], v[66:67]
    v_cvt_pk_bf16_f32 v12, v88, v89
    v_cvt_pk_bf16_f32 v13, v90, v91
    v_cvt_pk_bf16_f32 v14, v92, v93
    v_cvt_pk_bf16_f32 v15, v94, v95
    ds_write_b128 v43, v[12:15] offset:128
    v_pk_fma_f32 v[96:97], v[96:97], v[52:53], v[60:61]
    v_pk_fma_f32 v[98:99], v[98:99], v[54:55], v[62:63]
    v_pk_fma_f32 v[100:101], v[100:101], v[56:57], v[64:65]
    v_pk_fma_f32 v[102:103], v[102:103], v[58:59], v[66:67]
    v_cvt_pk_bf16_f32 v16, v96, v97
    v_cvt_pk_bf16_f32 v17, v98, v99
    v_cvt_pk_bf16_f32 v18, v100, v101
    v_cvt_pk_bf16_f32 v19, v102, v103
    ds_write_b128 v44, v[16:19] offset:256
    v_pk_fma_f32 v[104:105], v[104:105], v[52:53], v[60:61]
    v_pk_fma_f32 v[106:107], v[106:107], v[54:55], v[62:63]
    v_pk_fma_f32 v[108:109], v[108:109], v[56:57], v[64:65]
    v_pk_fma_f32 v[110:111], v[110:111], v[58:59], v[66:67]
    v_cvt_pk_bf16_f32 v20, v104, v105
    v_cvt_pk_bf16_f32 v21, v106, v107
    v_cvt_pk_bf16_f32 v22, v108, v109
    v_cvt_pk_bf16_f32 v23, v110, v111
    ds_write_b128 v44, v[20:23] offset:384
    v_pk_fma_f32 v[112:113], v[112:113], v[52:53], v[60:61]
    v_pk_fma_f32 v[114:115], v[114:115], v[54:55], v[62:63]
    v_pk_fma_f32 v[116:117], v[116:117], v[56:57], v[64:65]
    v_pk_fma_f32 v[118:119], v[118:119], v[58:59], v[66:67]
    v_cvt_pk_bf16_f32 v8, v112, v113
    v_cvt_pk_bf16_f32 v9, v114, v115
    v_cvt_pk_bf16_f32 v10, v116, v117
    v_cvt_pk_bf16_f32 v11, v118, v119
    ds_write_b128 v45, v[8:11] offset:512
    v_pk_fma_f32 v[120:121], v[120:121], v[52:53], v[60:61]
    v_pk_fma_f32 v[122:123], v[122:123], v[54:55], v[62:63]
    v_pk_fma_f32 v[124:125], v[124:125], v[56:57], v[64:65]
    v_pk_fma_f32 v[126:127], v[126:127], v[58:59], v[66:67]
    v_cvt_pk_bf16_f32 v12, v120, v121
    v_cvt_pk_bf16_f32 v13, v122, v123
    v_cvt_pk_bf16_f32 v14, v124, v125
    v_cvt_pk_bf16_f32 v15, v126, v127
    ds_write_b128 v45, v[12:15] offset:640
    v_pk_fma_f32 v[128:129], v[128:129], v[52:53], v[60:61]
    v_pk_fma_f32 v[130:131], v[130:131], v[54:55], v[62:63]
    v_pk_fma_f32 v[132:133], v[132:133], v[56:57], v[64:65]
    v_pk_fma_f32 v[134:135], v[134:135], v[58:59], v[66:67]
    v_cvt_pk_bf16_f32 v16, v128, v129
    v_cvt_pk_bf16_f32 v17, v130, v131
    v_cvt_pk_bf16_f32 v18, v132, v133
    v_cvt_pk_bf16_f32 v19, v134, v135
    ds_write_b128 v46, v[16:19] offset:768
    v_pk_fma_f32 v[136:137], v[136:137], v[52:53], v[60:61]
    v_pk_fma_f32 v[138:139], v[138:139], v[54:55], v[62:63]
    v_pk_fma_f32 v[140:141], v[140:141], v[56:57], v[64:65]
    v_pk_fma_f32 v[142:143], v[142:143], v[58:59], v[66:67]
    v_cvt_pk_bf16_f32 v20, v136, v137
    v_cvt_pk_bf16_f32 v21, v138, v139
    v_cvt_pk_bf16_f32 v22, v140, v141
    v_cvt_pk_bf16_f32 v23, v142, v143
    ds_write_b128 v46, v[20:23] offset:896
    s_waitcnt lgkmcnt(0)
    s_barrier
    s_cmp_ge_u32 s60, 4
    s_cbranch_scc1 P2_IDLE
    ds_read_b128 v[104:107], v40 offset:0
    ds_read_b64_tr_b16 v[124:125], v47 offset:128
    ds_read_b64_tr_b16 v[126:127], v47 offset:1664
    ds_read_b128 v[108:111], v40 offset:2048
    ds_read_b128 v[112:115], v40 offset:4096
    ds_read_b128 v[116:119], v40 offset:6144
    ds_read_b64_tr_b16 v[128:129], v47 offset:256
    ds_read_b64_tr_b16 v[130:131], v47 offset:1792
    ds_read_b64_tr_b16 v[120:121], v47 offset:0
    ds_read_b64_tr_b16 v[122:123], v47 offset:1536
    s_waitcnt lgkmcnt(7)
    v_mfma_f32_16x16x32_bf16 v[68:71], v[124:127], v[104:107], 0
    ds_read_b128 v[132:135], v41 offset:0
    s_waitcnt lgkmcnt(7)
    v_mfma_f32_16x16x32_bf16 v[72:75], v[124:127], v[108:111], 0
    ds_read_b64_tr_b16 v[152:153], v47 offset:12416
    s_waitcnt lgkmcnt(7)
    v_mfma_f32_16x16x32_bf16 v[76:79], v[124:127], v[112:115], 0
    ds_read_b64_tr_b16 v[154:155], v47 offset:13952
    s_waitcnt lgkmcnt(7)
    v_mfma_f32_16x16x32_bf16 v[80:83], v[124:127], v[116:119], 0
    ds_read_b128 v[136:139], v41 offset:2048
    s_waitcnt lgkmcnt(6)
    v_mfma_f32_16x16x32_bf16 v[84:87], v[104:107], v[128:131], 0
    ds_read_b128 v[140:143], v41 offset:4096
    v_mfma_f32_16x16x32_bf16 v[88:91], v[108:111], v[128:131], 0
    ds_read_b128 v[144:147], v41 offset:6144
    v_mfma_f32_16x16x32_bf16 v[92:95], v[112:115], v[128:131], 0
    ds_read_b64_tr_b16 v[156:157], v47 offset:12544
    v_mfma_f32_16x16x32_bf16 v[96:99], v[116:119], v[128:131], 0
    ds_read_b64_tr_b16 v[158:159], v47 offset:14080
    s_waitcnt lgkmcnt(8)
    v_mfma_f32_16x16x32_bf16 v[52:55], v[120:123], v[104:107], 0
    ds_read_b64_tr_b16 v[148:149], v47 offset:12288
    v_mfma_f32_16x16x32_bf16 v[56:59], v[120:123], v[108:111], 0
    ds_read_b64_tr_b16 v[150:151], v47 offset:13824
    v_mfma_f32_16x16x32_bf16 v[60:63], v[120:123], v[112:115], 0
    v_mfma_f32_16x16x32_bf16 v[64:67], v[120:123], v[116:119], 0
    s_waitcnt lgkmcnt(0)
    v_mfma_f32_16x16x32_bf16 v[68:71], v[152:155], v[132:135], v[68:71]
    s_barrier
    ds_read_b128 v[104:107], v40 offset:8192
    v_mfma_f32_16x16x32_bf16 v[72:75], v[152:155], v[136:139], v[72:75]
    ds_read_b64_tr_b16 v[124:125], v47 offset:24704
    v_mfma_f32_16x16x32_bf16 v[76:79], v[152:155], v[140:143], v[76:79]
    ds_read_b64_tr_b16 v[126:127], v47 offset:26240
    v_mfma_f32_16x16x32_bf16 v[80:83], v[152:155], v[144:147], v[80:83]
    ds_read_b128 v[108:111], v40 offset:10240
    v_mfma_f32_16x16x32_bf16 v[84:87], v[132:135], v[156:159], v[84:87]
    ds_read_b128 v[112:115], v40 offset:12288
    v_mfma_f32_16x16x32_bf16 v[88:91], v[136:139], v[156:159], v[88:91]
    ds_read_b128 v[116:119], v40 offset:14336
    v_mfma_f32_16x16x32_bf16 v[92:95], v[140:143], v[156:159], v[92:95]
    ds_read_b64_tr_b16 v[128:129], v47 offset:24832
    v_mfma_f32_16x16x32_bf16 v[96:99], v[144:147], v[156:159], v[96:99]
    ds_read_b64_tr_b16 v[130:131], v47 offset:26368
    v_mfma_f32_16x16x32_bf16 v[52:55], v[148:151], v[132:135], v[52:55]
    ds_read_b64_tr_b16 v[120:121], v47 offset:24576
    v_mfma_f32_16x16x32_bf16 v[56:59], v[148:151], v[136:139], v[56:59]
    ds_read_b64_tr_b16 v[122:123], v47 offset:26112
    v_mfma_f32_16x16x32_bf16 v[60:63], v[148:151], v[140:143], v[60:63]
    v_mfma_f32_16x16x32_bf16 v[64:67], v[148:151], v[144:147], v[64:67]
    s_waitcnt lgkmcnt(7)
    v_mfma_f32_16x16x32_bf16 v[68:71], v[124:127], v[104:107], v[68:71]
    ds_read_b128 v[132:135], v41 offset:8192
    s_waitcnt lgkmcnt(7)
    v_mfma_f32_16x16x32_bf16 v[72:75], v[124:127], v[108:111], v[72:75]
    ds_read_b64_tr_b16 v[152:153], v47 offset:36992
    s_waitcnt lgkmcnt(7)
    v_mfma_f32_16x16x32_bf16 v[76:79], v[124:127], v[112:115], v[76:79]
    ds_read_b64_tr_b16 v[154:155], v47 offset:38528
    s_waitcnt lgkmcnt(7)
    v_mfma_f32_16x16x32_bf16 v[80:83], v[124:127], v[116:119], v[80:83]
    ds_read_b128 v[136:139], v41 offset:10240
    s_waitcnt lgkmcnt(6)
    v_mfma_f32_16x16x32_bf16 v[84:87], v[104:107], v[128:131], v[84:87]
    ds_read_b128 v[140:143], v41 offset:12288
    v_mfma_f32_16x16x32_bf16 v[88:91], v[108:111], v[128:131], v[88:91]
    ds_read_b128 v[144:147], v41 offset:14336
    v_mfma_f32_16x16x32_bf16 v[92:95], v[112:115], v[128:131], v[92:95]
    ds_read_b64_tr_b16 v[156:157], v47 offset:37120
    v_mfma_f32_16x16x32_bf16 v[96:99], v[116:119], v[128:131], v[96:99]
    ds_read_b64_tr_b16 v[158:159], v47 offset:38656
    s_waitcnt lgkmcnt(8)
    v_mfma_f32_16x16x32_bf16 v[52:55], v[120:123], v[104:107], v[52:55]
    ds_read_b64_tr_b16 v[148:149], v47 offset:36864
    v_mfma_f32_16x16x32_bf16 v[56:59], v[120:123], v[108:111], v[56:59]
    ds_read_b64_tr_b16 v[150:151], v47 offset:38400
    v_mfma_f32_16x16x32_bf16 v[60:63], v[120:123], v[112:115], v[60:63]
    v_mfma_f32_16x16x32_bf16 v[64:67], v[120:123], v[116:119], v[64:67]
    s_waitcnt lgkmcnt(0)
    v_mfma_f32_16x16x32_bf16 v[68:71], v[152:155], v[132:135], v[68:71]
    s_barrier
    ds_read_b128 v[104:107], v40 offset:16384
    v_mfma_f32_16x16x32_bf16 v[72:75], v[152:155], v[136:139], v[72:75]
    ds_read_b64_tr_b16 v[124:125], v48 offset:128
    v_mfma_f32_16x16x32_bf16 v[76:79], v[152:155], v[140:143], v[76:79]
    ds_read_b64_tr_b16 v[126:127], v48 offset:1664
    v_mfma_f32_16x16x32_bf16 v[80:83], v[152:155], v[144:147], v[80:83]
    ds_read_b128 v[108:111], v40 offset:18432
    v_mfma_f32_16x16x32_bf16 v[84:87], v[132:135], v[156:159], v[84:87]
    ds_read_b128 v[112:115], v40 offset:20480
    v_mfma_f32_16x16x32_bf16 v[88:91], v[136:139], v[156:159], v[88:91]
    ds_read_b128 v[116:119], v40 offset:22528
    v_mfma_f32_16x16x32_bf16 v[92:95], v[140:143], v[156:159], v[92:95]
    ds_read_b64_tr_b16 v[128:129], v48 offset:256
    v_mfma_f32_16x16x32_bf16 v[96:99], v[144:147], v[156:159], v[96:99]
    ds_read_b64_tr_b16 v[130:131], v48 offset:1792
    v_mfma_f32_16x16x32_bf16 v[52:55], v[148:151], v[132:135], v[52:55]
    ds_read_b64_tr_b16 v[120:121], v48 offset:0
    v_mfma_f32_16x16x32_bf16 v[56:59], v[148:151], v[136:139], v[56:59]
    ds_read_b64_tr_b16 v[122:123], v48 offset:1536
    v_mfma_f32_16x16x32_bf16 v[60:63], v[148:151], v[140:143], v[60:63]
    v_mfma_f32_16x16x32_bf16 v[64:67], v[148:151], v[144:147], v[64:67]
    s_waitcnt lgkmcnt(7)
    v_mfma_f32_16x16x32_bf16 v[68:71], v[124:127], v[104:107], v[68:71]
    ds_read_b128 v[132:135], v41 offset:16384
    s_waitcnt lgkmcnt(7)
    v_mfma_f32_16x16x32_bf16 v[72:75], v[124:127], v[108:111], v[72:75]
    ds_read_b64_tr_b16 v[152:153], v48 offset:12416
    s_waitcnt lgkmcnt(7)
    v_mfma_f32_16x16x32_bf16 v[76:79], v[124:127], v[112:115], v[76:79]
    ds_read_b64_tr_b16 v[154:155], v48 offset:13952
    s_waitcnt lgkmcnt(7)
    v_mfma_f32_16x16x32_bf16 v[80:83], v[124:127], v[116:119], v[80:83]
    ds_read_b128 v[136:139], v41 offset:18432
    s_waitcnt lgkmcnt(6)
    v_mfma_f32_16x16x32_bf16 v[84:87], v[104:107], v[128:131], v[84:87]
    ds_read_b128 v[140:143], v41 offset:20480
    v_mfma_f32_16x16x32_bf16 v[88:91], v[108:111], v[128:131], v[88:91]
    ds_read_b128 v[144:147], v41 offset:22528
    v_mfma_f32_16x16x32_bf16 v[92:95], v[112:115], v[128:131], v[92:95]
    ds_read_b64_tr_b16 v[156:157], v48 offset:12544
    v_mfma_f32_16x16x32_bf16 v[96:99], v[116:119], v[128:131], v[96:99]
    ds_read_b64_tr_b16 v[158:159], v48 offset:14080
    s_waitcnt lgkmcnt(8)
    v_mfma_f32_16x16x32_bf16 v[52:55], v[120:123], v[104:107], v[52:55]
    ds_read_b64_tr_b16 v[148:149], v48 offset:12288
    v_mfma_f32_16x16x32_bf16 v[56:59], v[120:123], v[108:111], v[56:59]
    ds_read_b64_tr_b16 v[150:151], v48 offset:13824
    v_mfma_f32_16x16x32_bf16 v[60:63], v[120:123], v[112:115], v[60:63]
    v_mfma_f32_16x16x32_bf16 v[64:67], v[120:123], v[116:119], v[64:67]
    s_waitcnt lgkmcnt(0)
    v_mfma_f32_16x16x32_bf16 v[68:71], v[152:155], v[132:135], v[68:71]
    s_barrier
    ds_read_b128 v[104:107], v40 offset:24576
    v_mfma_f32_16x16x32_bf16 v[72:75], v[152:155], v[136:139], v[72:75]
    ds_read_b64_tr_b16 v[124:125], v48 offset:24704
    v_mfma_f32_16x16x32_bf16 v[76:79], v[152:155], v[140:143], v[76:79]
    ds_read_b64_tr_b16 v[126:127], v48 offset:26240
    v_mfma_f32_16x16x32_bf16 v[80:83], v[152:155], v[144:147], v[80:83]
    ds_read_b128 v[108:111], v40 offset:26624
    v_mfma_f32_16x16x32_bf16 v[84:87], v[132:135], v[156:159], v[84:87]
    ds_read_b128 v[112:115], v40 offset:28672
    v_mfma_f32_16x16x32_bf16 v[88:91], v[136:139], v[156:159], v[88:91]
    ds_read_b128 v[116:119], v40 offset:30720
    v_mfma_f32_16x16x32_bf16 v[92:95], v[140:143], v[156:159], v[92:95]
    ds_read_b64_tr_b16 v[128:129], v48 offset:24832
    v_mfma_f32_16x16x32_bf16 v[96:99], v[144:147], v[156:159], v[96:99]
    ds_read_b64_tr_b16 v[130:131], v48 offset:26368
    v_mfma_f32_16x16x32_bf16 v[52:55], v[148:151], v[132:135], v[52:55]
    ds_read_b64_tr_b16 v[120:121], v48 offset:24576
    v_mfma_f32_16x16x32_bf16 v[56:59], v[148:151], v[136:139], v[56:59]
    ds_read_b64_tr_b16 v[122:123], v48 offset:26112
    v_mfma_f32_16x16x32_bf16 v[60:63], v[148:151], v[140:143], v[60:63]
    v_mfma_f32_16x16x32_bf16 v[64:67], v[148:151], v[144:147], v[64:67]
    s_waitcnt lgkmcnt(7)
    v_mfma_f32_16x16x32_bf16 v[68:71], v[124:127], v[104:107], v[68:71]
    ds_read_b128 v[132:135], v41 offset:24576
    s_waitcnt lgkmcnt(7)
    v_mfma_f32_16x16x32_bf16 v[72:75], v[124:127], v[108:111], v[72:75]
    ds_read_b64_tr_b16 v[152:153], v48 offset:36992
    s_waitcnt lgkmcnt(7)
    v_mfma_f32_16x16x32_bf16 v[76:79], v[124:127], v[112:115], v[76:79]
    ds_read_b64_tr_b16 v[154:155], v48 offset:38528
    s_waitcnt lgkmcnt(7)
    v_mfma_f32_16x16x32_bf16 v[80:83], v[124:127], v[116:119], v[80:83]
    ds_read_b128 v[136:139], v41 offset:26624
    s_waitcnt lgkmcnt(6)
    v_mfma_f32_16x16x32_bf16 v[84:87], v[104:107], v[128:131], v[84:87]
    ds_read_b128 v[140:143], v41 offset:28672
    v_mfma_f32_16x16x32_bf16 v[88:91], v[108:111], v[128:131], v[88:91]
    ds_read_b128 v[144:147], v41 offset:30720
    v_mfma_f32_16x16x32_bf16 v[92:95], v[112:115], v[128:131], v[92:95]
    ds_read_b64_tr_b16 v[156:157], v48 offset:37120
    v_mfma_f32_16x16x32_bf16 v[96:99], v[116:119], v[128:131], v[96:99]
    ds_read_b64_tr_b16 v[158:159], v48 offset:38656
    s_waitcnt lgkmcnt(8)
    v_mfma_f32_16x16x32_bf16 v[52:55], v[120:123], v[104:107], v[52:55]
    ds_read_b64_tr_b16 v[148:149], v48 offset:36864
    v_mfma_f32_16x16x32_bf16 v[56:59], v[120:123], v[108:111], v[56:59]
    ds_read_b64_tr_b16 v[150:151], v48 offset:38400
    v_mfma_f32_16x16x32_bf16 v[60:63], v[120:123], v[112:115], v[60:63]
    v_mfma_f32_16x16x32_bf16 v[64:67], v[120:123], v[116:119], v[64:67]
    s_waitcnt lgkmcnt(0)
    v_mfma_f32_16x16x32_bf16 v[68:71], v[152:155], v[132:135], v[68:71]
    s_barrier
    ds_read_b128 v[104:107], v40 offset:32768
    v_mfma_f32_16x16x32_bf16 v[72:75], v[152:155], v[136:139], v[72:75]
    ds_read_b64_tr_b16 v[124:125], v47 offset:128
    v_mfma_f32_16x16x32_bf16 v[76:79], v[152:155], v[140:143], v[76:79]
    ds_read_b64_tr_b16 v[126:127], v47 offset:1664
    v_mfma_f32_16x16x32_bf16 v[80:83], v[152:155], v[144:147], v[80:83]
    ds_read_b128 v[108:111], v40 offset:34816
    v_mfma_f32_16x16x32_bf16 v[84:87], v[132:135], v[156:159], v[84:87]
    ds_read_b128 v[112:115], v40 offset:36864
    v_mfma_f32_16x16x32_bf16 v[88:91], v[136:139], v[156:159], v[88:91]
    ds_read_b128 v[116:119], v40 offset:38912
    v_mfma_f32_16x16x32_bf16 v[92:95], v[140:143], v[156:159], v[92:95]
    ds_read_b64_tr_b16 v[128:129], v47 offset:256
    v_mfma_f32_16x16x32_bf16 v[96:99], v[144:147], v[156:159], v[96:99]
    ds_read_b64_tr_b16 v[130:131], v47 offset:1792
    v_mfma_f32_16x16x32_bf16 v[52:55], v[148:151], v[132:135], v[52:55]
    ds_read_b64_tr_b16 v[120:121], v47 offset:0
    v_mfma_f32_16x16x32_bf16 v[56:59], v[148:151], v[136:139], v[56:59]
    ds_read_b64_tr_b16 v[122:123], v47 offset:1536
    v_mfma_f32_16x16x32_bf16 v[60:63], v[148:151], v[140:143], v[60:63]
    v_mfma_f32_16x16x32_bf16 v[64:67], v[148:151], v[144:147], v[64:67]
    s_waitcnt lgkmcnt(7)
    v_mfma_f32_16x16x32_bf16 v[68:71], v[124:127], v[104:107], v[68:71]
    ds_read_b128 v[132:135], v41 offset:32768
    s_waitcnt lgkmcnt(7)
    v_mfma_f32_16x16x32_bf16 v[72:75], v[124:127], v[108:111], v[72:75]
    ds_read_b64_tr_b16 v[152:153], v47 offset:12416
    s_waitcnt lgkmcnt(7)
    v_mfma_f32_16x16x32_bf16 v[76:79], v[124:127], v[112:115], v[76:79]
    ds_read_b64_tr_b16 v[154:155], v47 offset:13952
    s_waitcnt lgkmcnt(7)
    v_mfma_f32_16x16x32_bf16 v[80:83], v[124:127], v[116:119], v[80:83]
    ds_read_b128 v[136:139], v41 offset:34816
    s_waitcnt lgkmcnt(6)
    v_mfma_f32_16x16x32_bf16 v[84:87], v[104:107], v[128:131], v[84:87]
    ds_read_b128 v[140:143], v41 offset:36864
    v_mfma_f32_16x16x32_bf16 v[88:91], v[108:111], v[128:131], v[88:91]
    ds_read_b128 v[144:147], v41 offset:38912
    v_mfma_f32_16x16x32_bf16 v[92:95], v[112:115], v[128:131], v[92:95]
    ds_read_b64_tr_b16 v[156:157], v47 offset:12544
    v_mfma_f32_16x16x32_bf16 v[96:99], v[116:119], v[128:131], v[96:99]
    ds_read_b64_tr_b16 v[158:159], v47 offset:14080
    s_waitcnt lgkmcnt(8)
    v_mfma_f32_16x16x32_bf16 v[52:55], v[120:123], v[104:107], v[52:55]
    ds_read_b64_tr_b16 v[148:149], v47 offset:12288
    v_mfma_f32_16x16x32_bf16 v[56:59], v[120:123], v[108:111], v[56:59]
    ds_read_b64_tr_b16 v[150:151], v47 offset:13824
    v_mfma_f32_16x16x32_bf16 v[60:63], v[120:123], v[112:115], v[60:63]
    v_mfma_f32_16x16x32_bf16 v[64:67], v[120:123], v[116:119], v[64:67]
    s_waitcnt lgkmcnt(0)
    v_mfma_f32_16x16x32_bf16 v[68:71], v[152:155], v[132:135], v[68:71]
    s_barrier
    ds_read_b128 v[104:107], v40 offset:40960
    v_mfma_f32_16x16x32_bf16 v[72:75], v[152:155], v[136:139], v[72:75]
    ds_read_b64_tr_b16 v[124:125], v47 offset:24704
    v_mfma_f32_16x16x32_bf16 v[76:79], v[152:155], v[140:143], v[76:79]
    ds_read_b64_tr_b16 v[126:127], v47 offset:26240
    v_mfma_f32_16x16x32_bf16 v[80:83], v[152:155], v[144:147], v[80:83]
    ds_read_b128 v[108:111], v40 offset:43008
    v_mfma_f32_16x16x32_bf16 v[84:87], v[132:135], v[156:159], v[84:87]
    ds_read_b128 v[112:115], v40 offset:45056
    v_mfma_f32_16x16x32_bf16 v[88:91], v[136:139], v[156:159], v[88:91]
    ds_read_b128 v[116:119], v40 offset:47104
    v_mfma_f32_16x16x32_bf16 v[92:95], v[140:143], v[156:159], v[92:95]
    ds_read_b64_tr_b16 v[128:129], v47 offset:24832
    v_mfma_f32_16x16x32_bf16 v[96:99], v[144:147], v[156:159], v[96:99]
    ds_read_b64_tr_b16 v[130:131], v47 offset:26368
    v_mfma_f32_16x16x32_bf16 v[52:55], v[148:151], v[132:135], v[52:55]
    ds_read_b64_tr_b16 v[120:121], v47 offset:24576
    v_mfma_f32_16x16x32_bf16 v[56:59], v[148:151], v[136:139], v[56:59]
    ds_read_b64_tr_b16 v[122:123], v47 offset:26112
    v_mfma_f32_16x16x32_bf16 v[60:63], v[148:151], v[140:143], v[60:63]
    v_mfma_f32_16x16x32_bf16 v[64:67], v[148:151], v[144:147], v[64:67]
    s_waitcnt lgkmcnt(7)
    v_mfma_f32_16x16x32_bf16 v[68:71], v[124:127], v[104:107], v[68:71]
    ds_read_b128 v[132:135], v41 offset:40960
    s_waitcnt lgkmcnt(7)
    v_mfma_f32_16x16x32_bf16 v[72:75], v[124:127], v[108:111], v[72:75]
    ds_read_b64_tr_b16 v[152:153], v47 offset:36992
    s_waitcnt lgkmcnt(7)
    v_mfma_f32_16x16x32_bf16 v[76:79], v[124:127], v[112:115], v[76:79]
    ds_read_b64_tr_b16 v[154:155], v47 offset:38528
    s_waitcnt lgkmcnt(7)
    v_mfma_f32_16x16x32_bf16 v[80:83], v[124:127], v[116:119], v[80:83]
    ds_read_b128 v[136:139], v41 offset:43008
    s_waitcnt lgkmcnt(6)
    v_mfma_f32_16x16x32_bf16 v[84:87], v[104:107], v[128:131], v[84:87]
    ds_read_b128 v[140:143], v41 offset:45056
    v_mfma_f32_16x16x32_bf16 v[88:91], v[108:111], v[128:131], v[88:91]
    ds_read_b128 v[144:147], v41 offset:47104
    v_mfma_f32_16x16x32_bf16 v[92:95], v[112:115], v[128:131], v[92:95]
    ds_read_b64_tr_b16 v[156:157], v47 offset:37120
    v_mfma_f32_16x16x32_bf16 v[96:99], v[116:119], v[128:131], v[96:99]
    ds_read_b64_tr_b16 v[158:159], v47 offset:38656
    s_waitcnt lgkmcnt(8)
    v_mfma_f32_16x16x32_bf16 v[52:55], v[120:123], v[104:107], v[52:55]
    ds_read_b64_tr_b16 v[148:149], v47 offset:36864
    v_mfma_f32_16x16x32_bf16 v[56:59], v[120:123], v[108:111], v[56:59]
    ds_read_b64_tr_b16 v[150:151], v47 offset:38400
    v_mfma_f32_16x16x32_bf16 v[60:63], v[120:123], v[112:115], v[60:63]
    v_mfma_f32_16x16x32_bf16 v[64:67], v[120:123], v[116:119], v[64:67]
    s_waitcnt lgkmcnt(0)
    v_mfma_f32_16x16x32_bf16 v[68:71], v[152:155], v[132:135], v[68:71]
    s_barrier
    ds_read_b128 v[104:107], v40 offset:49152
    v_mfma_f32_16x16x32_bf16 v[72:75], v[152:155], v[136:139], v[72:75]
    ds_read_b64_tr_b16 v[124:125], v48 offset:128
    v_mfma_f32_16x16x32_bf16 v[76:79], v[152:155], v[140:143], v[76:79]
    ds_read_b64_tr_b16 v[126:127], v48 offset:1664
    v_mfma_f32_16x16x32_bf16 v[80:83], v[152:155], v[144:147], v[80:83]
    ds_read_b128 v[108:111], v40 offset:51200
    v_mfma_f32_16x16x32_bf16 v[84:87], v[132:135], v[156:159], v[84:87]
    ds_read_b128 v[112:115], v40 offset:53248
    v_mfma_f32_16x16x32_bf16 v[88:91], v[136:139], v[156:159], v[88:91]
    ds_read_b128 v[116:119], v40 offset:55296
    v_mfma_f32_16x16x32_bf16 v[92:95], v[140:143], v[156:159], v[92:95]
    ds_read_b64_tr_b16 v[128:129], v48 offset:256
    v_mfma_f32_16x16x32_bf16 v[96:99], v[144:147], v[156:159], v[96:99]
    ds_read_b64_tr_b16 v[130:131], v48 offset:1792
    v_mfma_f32_16x16x32_bf16 v[52:55], v[148:151], v[132:135], v[52:55]
    ds_read_b64_tr_b16 v[120:121], v48 offset:0
    v_mfma_f32_16x16x32_bf16 v[56:59], v[148:151], v[136:139], v[56:59]
    ds_read_b64_tr_b16 v[122:123], v48 offset:1536
    v_mfma_f32_16x16x32_bf16 v[60:63], v[148:151], v[140:143], v[60:63]
    v_mfma_f32_16x16x32_bf16 v[64:67], v[148:151], v[144:147], v[64:67]
    s_waitcnt lgkmcnt(7)
    v_mfma_f32_16x16x32_bf16 v[68:71], v[124:127], v[104:107], v[68:71]
    ds_read_b128 v[132:135], v41 offset:49152
    s_waitcnt lgkmcnt(7)
    v_mfma_f32_16x16x32_bf16 v[72:75], v[124:127], v[108:111], v[72:75]
    ds_read_b64_tr_b16 v[152:153], v48 offset:12416
    s_waitcnt lgkmcnt(7)
    v_mfma_f32_16x16x32_bf16 v[76:79], v[124:127], v[112:115], v[76:79]
    ds_read_b64_tr_b16 v[154:155], v48 offset:13952
    s_waitcnt lgkmcnt(7)
    v_mfma_f32_16x16x32_bf16 v[80:83], v[124:127], v[116:119], v[80:83]
    ds_read_b128 v[136:139], v41 offset:51200
    s_waitcnt lgkmcnt(6)
    v_mfma_f32_16x16x32_bf16 v[84:87], v[104:107], v[128:131], v[84:87]
    ds_read_b128 v[140:143], v41 offset:53248
    v_mfma_f32_16x16x32_bf16 v[88:91], v[108:111], v[128:131], v[88:91]
    ds_read_b128 v[144:147], v41 offset:55296
    v_mfma_f32_16x16x32_bf16 v[92:95], v[112:115], v[128:131], v[92:95]
    ds_read_b64_tr_b16 v[156:157], v48 offset:12544
    v_mfma_f32_16x16x32_bf16 v[96:99], v[116:119], v[128:131], v[96:99]
    ds_read_b64_tr_b16 v[158:159], v48 offset:14080
    s_waitcnt lgkmcnt(8)
    v_mfma_f32_16x16x32_bf16 v[52:55], v[120:123], v[104:107], v[52:55]
    ds_read_b64_tr_b16 v[148:149], v48 offset:12288
    v_mfma_f32_16x16x32_bf16 v[56:59], v[120:123], v[108:111], v[56:59]
    ds_read_b64_tr_b16 v[150:151], v48 offset:13824
    v_mfma_f32_16x16x32_bf16 v[60:63], v[120:123], v[112:115], v[60:63]
    v_mfma_f32_16x16x32_bf16 v[64:67], v[120:123], v[116:119], v[64:67]
    s_waitcnt lgkmcnt(0)
    v_mfma_f32_16x16x32_bf16 v[68:71], v[152:155], v[132:135], v[68:71]
    s_barrier
    ds_read_b128 v[104:107], v40 offset:57344
    v_mfma_f32_16x16x32_bf16 v[72:75], v[152:155], v[136:139], v[72:75]
    ds_read_b64_tr_b16 v[124:125], v48 offset:24704
    v_mfma_f32_16x16x32_bf16 v[76:79], v[152:155], v[140:143], v[76:79]
    ds_read_b64_tr_b16 v[126:127], v48 offset:26240
    v_mfma_f32_16x16x32_bf16 v[80:83], v[152:155], v[144:147], v[80:83]
    ds_read_b128 v[108:111], v40 offset:59392
    v_mfma_f32_16x16x32_bf16 v[84:87], v[132:135], v[156:159], v[84:87]
    ds_read_b128 v[112:115], v40 offset:61440
    v_mfma_f32_16x16x32_bf16 v[88:91], v[136:139], v[156:159], v[88:91]
    ds_read_b128 v[116:119], v40 offset:63488
    v_mfma_f32_16x16x32_bf16 v[92:95], v[140:143], v[156:159], v[92:95]
    ds_read_b64_tr_b16 v[128:129], v48 offset:24832
    v_mfma_f32_16x16x32_bf16 v[96:99], v[144:147], v[156:159], v[96:99]
    ds_read_b64_tr_b16 v[130:131], v48 offset:26368
    v_mfma_f32_16x16x32_bf16 v[52:55], v[148:151], v[132:135], v[52:55]
    ds_read_b64_tr_b16 v[120:121], v48 offset:24576
    v_mfma_f32_16x16x32_bf16 v[56:59], v[148:151], v[136:139], v[56:59]
    ds_read_b64_tr_b16 v[122:123], v48 offset:26112
    v_mfma_f32_16x16x32_bf16 v[60:63], v[148:151], v[140:143], v[60:63]
    v_mfma_f32_16x16x32_bf16 v[64:67], v[148:151], v[144:147], v[64:67]
    s_waitcnt lgkmcnt(7)
    v_mfma_f32_16x16x32_bf16 v[68:71], v[124:127], v[104:107], v[68:71]
    ds_read_b128 v[132:135], v41 offset:57344
    s_waitcnt lgkmcnt(7)
    v_mfma_f32_16x16x32_bf16 v[72:75], v[124:127], v[108:111], v[72:75]
    ds_read_b64_tr_b16 v[152:153], v48 offset:36992
    s_waitcnt lgkmcnt(7)
    v_mfma_f32_16x16x32_bf16 v[76:79], v[124:127], v[112:115], v[76:79]
    ds_read_b64_tr_b16 v[154:155], v48 offset:38528
    s_waitcnt lgkmcnt(7)
    v_mfma_f32_16x16x32_bf16 v[80:83], v[124:127], v[116:119], v[80:83]
    ds_read_b128 v[136:139], v41 offset:59392
    s_waitcnt lgkmcnt(6)
    v_mfma_f32_16x16x32_bf16 v[84:87], v[104:107], v[128:131], v[84:87]
    ds_read_b128 v[140:143], v41 offset:61440
    v_mfma_f32_16x16x32_bf16 v[88:91], v[108:111], v[128:131], v[88:91]
    ds_read_b128 v[144:147], v41 offset:63488
    v_mfma_f32_16x16x32_bf16 v[92:95], v[112:115], v[128:131], v[92:95]
    ds_read_b64_tr_b16 v[156:157], v48 offset:37120
    v_mfma_f32_16x16x32_bf16 v[96:99], v[116:119], v[128:131], v[96:99]
    ds_read_b64_tr_b16 v[158:159], v48 offset:38656
    s_waitcnt lgkmcnt(8)
    v_mfma_f32_16x16x32_bf16 v[52:55], v[120:123], v[104:107], v[52:55]
    ds_read_b64_tr_b16 v[148:149], v48 offset:36864
    v_mfma_f32_16x16x32_bf16 v[56:59], v[120:123], v[108:111], v[56:59]
    ds_read_b64_tr_b16 v[150:151], v48 offset:38400
    v_mfma_f32_16x16x32_bf16 v[60:63], v[120:123], v[112:115], v[60:63]
    v_mfma_f32_16x16x32_bf16 v[64:67], v[120:123], v[116:119], v[64:67]
    s_waitcnt lgkmcnt(7)
    v_mfma_f32_16x16x32_bf16 v[68:71], v[152:155], v[132:135], v[68:71]
    s_waitcnt lgkmcnt(6)
    v_mfma_f32_16x16x32_bf16 v[72:75], v[152:155], v[136:139], v[72:75]
    s_waitcnt lgkmcnt(5)
    v_mfma_f32_16x16x32_bf16 v[76:79], v[152:155], v[140:143], v[76:79]
    s_waitcnt lgkmcnt(4)
    v_mfma_f32_16x16x32_bf16 v[80:83], v[152:155], v[144:147], v[80:83]
    s_waitcnt lgkmcnt(2)
    v_mfma_f32_16x16x32_bf16 v[84:87], v[132:135], v[156:159], v[84:87]
    v_mfma_f32_16x16x32_bf16 v[88:91], v[136:139], v[156:159], v[88:91]
    v_mfma_f32_16x16x32_bf16 v[92:95], v[140:143], v[156:159], v[92:95]
    v_cvt_pk_bf16_f32 v16, v68, v69
    v_cvt_pk_bf16_f32 v17, v70, v71
    v_cvt_pk_bf16_f32 v18, v72, v73
    v_mfma_f32_16x16x32_bf16 v[96:99], v[144:147], v[156:159], v[96:99]
    v_cvt_pk_bf16_f32 v19, v74, v75
    v_permlane16_swap_b32 v16, v18
    s_waitcnt lgkmcnt(0)
    v_mfma_f32_16x16x32_bf16 v[52:55], v[148:151], v[132:135], v[52:55]
    v_permlane16_swap_b32 v17, v19
    buffer_store_dwordx4 v[16:19], v42, s[52:55], s5 offen offset:0 sc1
    v_mfma_f32_16x16x32_bf16 v[56:59], v[148:151], v[136:139], v[56:59]
    v_cvt_pk_bf16_f32 v20, v76, v77
    v_cvt_pk_bf16_f32 v21, v78, v79
    v_cvt_pk_bf16_f32 v22, v80, v81
    v_mfma_f32_16x16x32_bf16 v[60:63], v[148:151], v[140:143], v[60:63]
    v_cvt_pk_bf16_f32 v23, v82, v83
    v_permlane16_swap_b32 v20, v22
    v_mfma_f32_16x16x32_bf16 v[64:67], v[148:151], v[144:147], v[64:67]
    v_permlane16_swap_b32 v21, v23
    buffer_store_dwordx4 v[20:23], v42, s[52:55], s5 offen offset:1024 sc1
    v_cvt_pk_bf16_f32 v24, v84, v85
    v_cvt_pk_bf16_f32 v25, v86, v87
    v_cvt_pk_bf16_f32 v26, v88, v89
    v_cvt_pk_bf16_f32 v27, v90, v91
    s_nop 0
    v_permlane32_swap_b32 v24, v26
    v_permlane32_swap_b32 v25, v27
    buffer_store_dwordx4 v[24:27], v42, s[52:55], s6 offen offset:0 sc1
    v_cvt_pk_bf16_f32 v28, v92, v93
    v_cvt_pk_bf16_f32 v29, v94, v95
    v_cvt_pk_bf16_f32 v30, v96, v97
    v_cvt_pk_bf16_f32 v31, v98, v99
    s_nop 0
    v_permlane32_swap_b32 v28, v30
    v_permlane32_swap_b32 v29, v31
    buffer_store_dwordx4 v[28:31], v42, s[52:55], s6 offen offset:1024 sc1
    v_pk_mul_f32 v[52:53], v[52:53], s[8:9] op_sel_hi:[1,0]
    v_pk_mul_f32 v[54:55], v[54:55], s[8:9] op_sel_hi:[1,0]
    v_pk_mul_f32 v[56:57], v[56:57], s[8:9] op_sel_hi:[1,0]
    v_pk_mul_f32 v[58:59], v[58:59], s[8:9] op_sel_hi:[1,0]
    v_cvt_pk_bf16_f32 v8, v52, v53
    v_cvt_pk_bf16_f32 v9, v54, v55
    v_cvt_pk_bf16_f32 v10, v56, v57
    v_cvt_pk_bf16_f32 v11, v58, v59
    s_nop 0
    v_permlane16_swap_b32 v8, v10
    v_permlane16_swap_b32 v9, v11
    buffer_store_dwordx4 v[8:11], v42, s[52:55], s4 offen offset:0 sc1
    v_pk_mul_f32 v[60:61], v[60:61], s[8:9] op_sel_hi:[1,0]
    v_pk_mul_f32 v[62:63], v[62:63], s[8:9] op_sel_hi:[1,0]
    v_pk_mul_f32 v[64:65], v[64:65], s[8:9] op_sel_hi:[1,0]
    v_pk_mul_f32 v[66:67], v[66:67], s[8:9] op_sel_hi:[1,0]
    v_cvt_pk_bf16_f32 v12, v60, v61
    v_cvt_pk_bf16_f32 v13, v62, v63
    v_cvt_pk_bf16_f32 v14, v64, v65
    v_cvt_pk_bf16_f32 v15, v66, v67
    s_nop 0
    v_permlane16_swap_b32 v12, v14
    v_permlane16_swap_b32 v13, v15
    buffer_store_dwordx4 v[12:15], v42, s[52:55], s4 offen offset:1024 sc1
    s_waitcnt vmcnt(0)
    s_barrier
    s_branch P2_END
P2_IDLE:
    s_mov_b32 s61, 8
BAR_1:
    s_barrier
    s_sub_u32 s61, s61, 1
    s_cmp_lg_u32 s61, 0
    s_cbranch_scc1 BAR_1
    s_waitcnt vmcnt(0)
    s_branch P2_END
P2_X:
    s_barrier
    s_sleep 8
    s_waitcnt lgkmcnt(0)
    s_and_b32 s97, s97, 0xffff
    s_and_b32 s29, s29, 0xffff
    s_and_b32 s33, s33, 0xffff
    s_and_b32 s53, s53, 0xffff
    s_mov_b32 s54, 0x1980000
    s_mov_b32 s55, 0x00020000
    s_and_b32 s37, s37, 0xffff
    s_mov_b32 s38, 0x80000
    s_mov_b32 s39, 0x00020000
    s_and_b32 s41, s41, 0xffff
    s_mov_b32 s42, 0x1c0000
    s_mov_b32 s43, 0x00020000
    s_and_b32 s45, s45, 0xffff
    s_mov_b32 s46, 0x1c0000
    s_mov_b32 s47, 0x00020000
    s_and_b32 s49, s49, 0xffff
    s_mov_b32 s50, 0x1c0000
    s_mov_b32 s51, 0x00020000
    s_and_b32 s57, s57, 0xffff
    s_mov_b32 s58, 0x200000
    s_mov_b32 s59, 0x00020000
    s_mov_b32 s4, s64
    s_and_b32 s5, s65, 0xffff
    s_mov_b32 s6, 0x100
    s_mov_b32 s7, 0x00020000
    s_and_b32 s25, s2, 1
    s_lshl_b32 s25, s25, 2
    s_bfe_u32 s26, s2, 0x20003
    s_add_u32 s25, s25, s26
    s_bfe_u32 s26, s2, 0x20001
    s_lshl_b32 s26, s26, 3
    s_lshr_b32 s27, s2, 5
    s_add_u32 s26, s26, s27
    v_mov_b32 v30, 0
    s_cmp_eq_u32 s60, 10
    s_cbranch_scc1 P2_X10
    v_lshrrev_b32 v9, 1, v1
    v_mul_u32_u24 v9, 6144, v9
    v_and_b32 v10, 1, v1
    v_lshl_add_u32 v9, v10, 4, v9
    v_lshrrev_b32 v11, 4, v1
    v_bfe_u32 v13, v1, 2, 2
    v_lshl_add_u32 v13, v11, 3, v13
    v_lshlrev_b32 v13, 5, v13
    v_and_b32 v14, 3, v1
    v_lshl_add_u32 v13, v14, 3, v13
    v_add_u32 v13, 149504, v13
    v_mov_b32 v16, 0
    v_mov_b32 v17, 0
    v_mov_b32 v18, 0
    v_mov_b32 v19, 0
    s_and_b32 s16, s2, 7
    s_lshl_b32 s16, s16, 4
    s_lshr_b32 s17, s2, 3
    s_add_u32 s16, s16, s17
    s_add_u32 s16, s16, 64
    s_lshl_b32 s17, s16, 5
    v_lshlrev_b32 v20, 4, v1
    s_setprio 3
    s_mov_b32 s61, 6
BAR_2:
    s_barrier
    s_sub_u32 s61, s61, 1
    s_cmp_lg_u32 s61, 0
    s_cbranch_scc1 BAR_2
    buffer_load_dwordx2 v[28:29], v30, s[4:7], 0 offen sc1
    global_load_dwordx4 v[96:99], v20, s[14:15]
    s_barrier
    s_barrier
    s_barrier
    s_branch P2_END
P2_X10:
    v_lshrrev_b32 v3, 3, v1
    v_bfe_u32 v8, v1, 2, 1
    v_bfe_u32 v9, v1, 4, 1
    v_xor_b32 v8, v8, v9
    v_lshlrev_b32 v10, 10, v3
    v_lshl_add_u32 v10, v8, 6, v10
    v_and_b32 v8, 3, v1
    v_lshl_add_u32 v10, v8, 4, v10
    s_mov_b32 s23, 0
    s_mov_b32 s24, 0
    v_lshlrev_b32 v12, 4, v1
    s_lshl_b32 s20, s23, 12
    v_add_u32 v12, s20, v12
    v_lshrrev_b32 v17, 5, v1
    v_bfe_u32 v16, v1, 2, 2
    v_lshl_add_u32 v18, v17, 2, v16
    v_lshlrev_b32 v14, 7, v18
    v_lshrrev_b32 v16, 1, v16
    v_xor_b32 v16, s24, v16
    v_lshl_add_u32 v14, v16, 6, v14
    v_bfe_u32 v16, v1, 4, 1
    v_lshl_add_u32 v14, v16, 5, v14
    v_and_b32 v16, 3, v1
    v_lshl_add_u32 v14, v16, 3, v14
    v_add_u32 v14, 8192, v14
    v_add_u32 v13, 65536, v12
    v_add_u32 v15, 65536, v14
    v_add_u32 v14, 145408, v14
    v_and_b32 v15, 32, v1
    v_lshl_add_u32 v14, v15, 4, v14
    v_xor_b32 v15, 64, v14
    v_add_u32 v13, 153600, v12
    s_and_b32 s12, s2, 7
    s_lshr_b32 s13, s2, 3
    s_lshl_b32 s16, s13, 16
    s_lshl_b32 s17, s12, 7
    s_add_u32 s16, s16, s17
    s_mul_i32 s17, s12, 224*1024
    s_lshl_b32 s18, s13, 12
    s_add_u32 s17, s17, s18
    s_add_u32 s17, s17, 20971520
    s_add_u32 s18, s17, 112*1024
    s_lshl_b32 s19, s12, 8
    s_and_b32 s12, s13, 16
    s_lshl3_add_u32 s19, s12, s19
    s_and_b32 s12, s13, 15
    s_lshl2_add_u32 s19, s12, s19
    s_add_u32 s19, s19, 2112
    s_setprio 3
    s_mov_b32 s61, 6
BAR_3:
    s_barrier
    s_sub_u32 s61, s61, 1
    s_cmp_lg_u32 s61, 0
    s_cbranch_scc1 BAR_3
    buffer_load_dwordx2 v[28:29], v30, s[4:7], 0 offen sc1
    s_cmp_ge_u32 s2, 224
    s_cbranch_scc1 P2_X10B
    buffer_load_dwordx4 v[32:35], v10, s[48:51], s16 offen
    s_add_u32 s16, s16, 8192
    buffer_load_dwordx4 v[36:39], v10, s[48:51], s16 offen
    s_add_u32 s16, s16, 8192
    buffer_load_dwordx4 v[40:43], v10, s[48:51], s16 offen
    s_add_u32 s16, s16, 8192
    buffer_load_dwordx4 v[44:47], v10, s[48:51], s16 offen
    s_add_u32 s16, s16, 8192
    buffer_load_dwordx4 v[48:51], v10, s[48:51], s16 offen
    s_add_u32 s16, s16, 8192
    buffer_load_dwordx4 v[52:55], v10, s[48:51], s16 offen
    s_add_u32 s16, s16, 8192
    buffer_load_dwordx4 v[56:59], v10, s[48:51], s16 offen
    s_add_u32 s16, s16, 8192
    buffer_load_dwordx4 v[60:63], v10, s[48:51], s16 offen
    s_add_u32 s16, s16, 8192
P2_X10B:
    s_barrier
    s_barrier
    s_barrier
    s_branch P2_END
P2_LOADER:
    s_waitcnt lgkmcnt(0)
    s_and_b32 s97, s97, 0xffff
    s_and_b32 s29, s29, 0xffff
    s_and_b32 s33, s33, 0xffff
    s_and_b32 s53, s53, 0xffff
    s_mov_b32 s54, 0x1980000
    s_mov_b32 s55, 0x00020000
    s_and_b32 s37, s37, 0xffff
    s_mov_b32 s38, 0x80000
    s_mov_b32 s39, 0x00020000
    s_and_b32 s41, s41, 0xffff
    s_mov_b32 s42, 0x1c0000
    s_mov_b32 s43, 0x00020000
    s_and_b32 s45, s45, 0xffff
    s_mov_b32 s46, 0x1c0000
    s_mov_b32 s47, 0x00020000
    s_and_b32 s49, s49, 0xffff
    s_mov_b32 s50, 0x1c0000
    s_mov_b32 s51, 0x00020000
    s_and_b32 s57, s57, 0xffff
    s_mov_b32 s58, 0x200000
    s_mov_b32 s59, 0x00020000
    s_mov_b32 s4, s64
    s_and_b32 s5, s65, 0xffff
    s_mov_b32 s6, 0x100
    s_mov_b32 s7, 0x00020000
    s_and_b32 s25, s2, 1
    s_lshl_b32 s25, s25, 2
    s_bfe_u32 s26, s2, 0x20003
    s_add_u32 s25, s25, s26
    s_bfe_u32 s26, s2, 0x20001
    s_lshl_b32 s26, s26, 3
    s_lshr_b32 s27, s2, 5
    s_add_u32 s26, s26, s27
    v_mov_b32 v28, 327680
    v_mov_b32 v29, 327680
    s_branch P2_LSET
P2_MOD:
    s_waitcnt lgkmcnt(0)
    s_and_b32 s97, s97, 0xffff
    s_and_b32 s29, s29, 0xffff
    s_and_b32 s33, s33, 0xffff
    s_and_b32 s53, s53, 0xffff
    s_mov_b32 s54, 0x1980000
    s_mov_b32 s55, 0x00020000
    s_and_b32 s37, s37, 0xffff
    s_mov_b32 s38, 0x80000
    s_mov_b32 s39, 0x00020000
    s_and_b32 s41, s41, 0xffff
    s_mov_b32 s42, 0x1c0000
    s_mov_b32 s43, 0x00020000
    s_and_b32 s45, s45, 0xffff
    s_mov_b32 s46, 0x1c0000
    s_mov_b32 s47, 0x00020000
    s_and_b32 s49, s49, 0xffff
    s_mov_b32 s50, 0x1c0000
    s_mov_b32 s51, 0x00020000
    s_and_b32 s57, s57, 0xffff
    s_mov_b32 s58, 0x200000
    s_mov_b32 s59, 0x00020000
    s_mov_b32 s4, s64
    s_and_b32 s5, s65, 0xffff
    s_mov_b32 s6, 0x100
    s_mov_b32 s7, 0x00020000
    s_and_b32 s25, s2, 1
    s_lshl_b32 s25, s25, 2
    s_bfe_u32 s26, s2, 0x20003
    s_add_u32 s25, s25, s26
    s_bfe_u32 s26, s2, 0x20001
    s_lshl_b32 s26, s26, 3
    s_lshr_b32 s27, s2, 5
    s_add_u32 s26, s26, s27
    v_lshrrev_b32 v9, 1, v1
    v_mul_u32_u24 v9, 6144, v9
    v_and_b32 v10, 1, v1
    v_lshl_add_u32 v9, v10, 4, v9
    v_lshrrev_b32 v11, 4, v1
    v_bfe_u32 v13, v1, 2, 2
    v_lshl_add_u32 v13, v11, 3, v13
    v_lshlrev_b32 v13, 5, v13
    v_and_b32 v14, 3, v1
    v_lshl_add_u32 v13, v14, 3, v13
    v_add_u32 v13, 139264, v13
    v_mov_b32 v16, 0
    v_mov_b32 v17, 0
    v_mov_b32 v18, 0
    v_mov_b32 v19, 0
    s_or_b32 s13, s13, 0x40000000
    v_mov_b32 v26, s12
    v_mov_b32 v27, s13
    v_and_b32 v28, 12, v1
    v_lshlrev_b32 v28, 2, v28
    v_lshrrev_b32 v29, 4, v1
    v_lshl_add_u32 v28, v29, 15, v28
    v_and_b32 v29, 3, v1
    v_lshl_add_u32 v28, v29, 13, v28
    s_lshl_b32 s18, s16, 7
    s_add_u32 s18, s18, 327680
    v_add_u32 v28, s18, v28
    s_lshl_b32 s18, s16, 7
    s_add_u32 s18, s18, 393216
    v_mov_b32 v29, s18
    s_waitcnt vmcnt(12)
    v_lshlrev_b32 v100, 16, v96
    v_and_b32 v101, 0xffff0000, v96
    v_lshlrev_b32 v102, 16, v97
    v_and_b32 v103, 0xffff0000, v97
    v_lshlrev_b32 v104, 16, v98
    v_and_b32 v105, 0xffff0000, v98
    v_lshlrev_b32 v106, 16, v99
    v_and_b32 v107, 0xffff0000, v99
    v_mul_f32 v108, 0xbfb8aa3b, v100
    v_mul_f32 v109, 0xbfb8aa3b, v101
    v_mul_f32 v110, 0xbfb8aa3b, v102
    v_mul_f32 v111, 0xbfb8aa3b, v103
    v_mul_f32 v112, 0xbfb8aa3b, v104
    v_mul_f32 v113, 0xbfb8aa3b, v105
    v_mul_f32 v114, 0xbfb8aa3b, v106
    v_mul_f32 v115, 0xbfb8aa3b, v107
    v_exp_f32 v108, v108
    v_exp_f32 v109, v109
    v_exp_f32 v110, v110
    v_exp_f32 v111, v111
    v_exp_f32 v112, v112
    v_exp_f32 v113, v113
    v_exp_f32 v114, v114
    v_exp_f32 v115, v115
    v_add_f32 v108, 1.0, v108
    v_add_f32 v109, 1.0, v109
    v_add_f32 v110, 1.0, v110
    v_add_f32 v111, 1.0, v111
    v_add_f32 v112, 1.0, v112
    v_add_f32 v113, 1.0, v113
    v_add_f32 v114, 1.0, v114
    v_add_f32 v115, 1.0, v115
    v_rcp_f32 v108, v108
    v_rcp_f32 v109, v109
    v_rcp_f32 v110, v110
    v_rcp_f32 v111, v111
    v_rcp_f32 v112, v112
    v_rcp_f32 v113, v113
    v_rcp_f32 v114, v114
    v_rcp_f32 v115, v115
    v_mul_f32 v100, v100, v108
    v_mul_f32 v101, v101, v109
    v_mul_f32 v102, v102, v110
    v_mul_f32 v103, v103, v111
    v_mul_f32 v104, v104, v112
    v_mul_f32 v105, v105, v113
    v_mul_f32 v106, v106, v114
    v_mul_f32 v107, v107, v115
    v_cvt_pk_bf16_f32 v96, v100, v101
    v_cvt_pk_bf16_f32 v97, v102, v103
    v_cvt_pk_bf16_f32 v98, v104, v105
    v_cvt_pk_bf16_f32 v99, v106, v107
    v_add_u32 v20, 155648, v20
    ds_write_b128 v20, v[96:99]
    v_lshrrev_b32 v21, 4, v1
    v_lshlrev_b32 v21, 4, v21
    v_add_u32 v21, 155648, v21
    s_waitcnt lgkmcnt(0)
    ds_read_b128 v[32:35], v21 offset:0
    ds_read_b128 v[36:39], v21 offset:64
    ds_read_b128 v[40:43], v21 offset:128
    ds_read_b128 v[44:47], v21 offset:192
    ds_read_b128 v[48:51], v21 offset:256
    ds_read_b128 v[52:55], v21 offset:320
    ds_read_b128 v[56:59], v21 offset:384
    ds_read_b128 v[60:63], v21 offset:448
    ds_read_b128 v[64:67], v21 offset:512
    ds_read_b128 v[68:71], v21 offset:576
    ds_read_b128 v[72:75], v21 offset:640
    ds_read_b128 v[76:79], v21 offset:704
    ds_read_b128 v[80:83], v21 offset:768
    ds_read_b128 v[84:87], v21 offset:832
    ds_read_b128 v[88:91], v21 offset:896
    ds_read_b128 v[92:95], v21 offset:960
    s_waitcnt vmcnt(8)
    ds_read_b64_tr_b16 v[96:97], v13 offset:0
    ds_read_b64_tr_b16 v[98:99], v13 offset:128
    ds_read_b64_tr_b16 v[100:101], v13 offset:1024
    ds_read_b64_tr_b16 v[102:103], v13 offset:1152
    ds_read_b64_tr_b16 v[104:105], v13 offset:2048
    ds_read_b64_tr_b16 v[106:107], v13 offset:2176
    ds_read_b64_tr_b16 v[108:109], v13 offset:3072
    ds_read_b64_tr_b16 v[110:111], v13 offset:3200
    ds_read_b64_tr_b16 v[112:113], v13 offset:4096
    ds_read_b64_tr_b16 v[114:115], v13 offset:4224
    ds_read_b64_tr_b16 v[116:117], v13 offset:5120
    ds_read_b64_tr_b16 v[118:119], v13 offset:5248
    ds_read_b64_tr_b16 v[120:121], v13 offset:6144
    ds_read_b64_tr_b16 v[122:123], v13 offset:6272
    ds_read_b64_tr_b16 v[124:125], v13 offset:7168
    ds_read_b64_tr_b16 v[126:127], v13 offset:7296
    s_waitcnt lgkmcnt(0)
    v_mfma_f32_16x16x32_bf16 v[16:19], v[32:35], v[96:99], v[16:19]
    v_mfma_f32_16x16x32_bf16 v[16:19], v[36:39], v[100:103], v[16:19]
    v_mfma_f32_16x16x32_bf16 v[16:19], v[40:43], v[104:107], v[16:19]
    v_mfma_f32_16x16x32_bf16 v[16:19], v[44:47], v[108:111], v[16:19]
    v_mfma_f32_16x16x32_bf16 v[16:19], v[48:51], v[112:115], v[16:19]
    v_mfma_f32_16x16x32_bf16 v[16:19], v[52:55], v[116:119], v[16:19]
    v_mfma_f32_16x16x32_bf16 v[16:19], v[56:59], v[120:123], v[16:19]
    v_mfma_f32_16x16x32_bf16 v[16:19], v[60:63], v[124:127], v[16:19]
    s_waitcnt vmcnt(0)
    ds_read_b64_tr_b16 v[96:97], v13 offset:8192
    ds_read_b64_tr_b16 v[98:99], v13 offset:8320
    ds_read_b64_tr_b16 v[100:101], v13 offset:9216
    ds_read_b64_tr_b16 v[102:103], v13 offset:9344
    ds_read_b64_tr_b16 v[104:105], v13 offset:10240
    ds_read_b64_tr_b16 v[106:107], v13 offset:10368
    ds_read_b64_tr_b16 v[108:109], v13 offset:11264
    ds_read_b64_tr_b16 v[110:111], v13 offset:11392
    ds_read_b64_tr_b16 v[112:113], v13 offset:12288
    ds_read_b64_tr_b16 v[114:115], v13 offset:12416
    ds_read_b64_tr_b16 v[116:117], v13 offset:13312
    ds_read_b64_tr_b16 v[118:119], v13 offset:13440
    ds_read_b64_tr_b16 v[120:121], v13 offset:14336
    ds_read_b64_tr_b16 v[122:123], v13 offset:14464
    ds_read_b64_tr_b16 v[124:125], v13 offset:15360
    ds_read_b64_tr_b16 v[126:127], v13 offset:15488
    s_waitcnt lgkmcnt(0)
    v_mfma_f32_16x16x32_bf16 v[16:19], v[64:67], v[96:99], v[16:19]
    v_mfma_f32_16x16x32_bf16 v[16:19], v[68:71], v[100:103], v[16:19]
    v_mfma_f32_16x16x32_bf16 v[16:19], v[72:75], v[104:107], v[16:19]
    v_mfma_f32_16x16x32_bf16 v[16:19], v[76:79], v[108:111], v[16:19]
    v_mfma_f32_16x16x32_bf16 v[16:19], v[80:83], v[112:115], v[16:19]
    v_mfma_f32_16x16x32_bf16 v[16:19], v[84:87], v[116:119], v[16:19]
    v_mfma_f32_16x16x32_bf16 v[16:19], v[88:91], v[120:123], v[16:19]
    v_mfma_f32_16x16x32_bf16 v[16:19], v[92:95], v[124:127], v[16:19]
    s_nop 7
    v_cvt_pk_bf16_f32 v16, v16, v16
    v_lshlrev_b32 v16, 16, v16
    s_cmp_lt_u32 s16, 32
    s_cbranch_scc1 P2_NOADD
    v_add_f32 v16, 1.0, v16
    v_cvt_pk_bf16_f32 v16, v16, v16
    v_lshlrev_b32 v16, 16, v16
P2_NOADD:
    s_nop 1
    v_mov_b32_dpp v17, v16 quad_perm:[1,1,1,1] row_mask:0xf bank_mask:0xf
    v_mov_b32_dpp v18, v16 quad_perm:[2,2,2,2] row_mask:0xf bank_mask:0xf
    v_mov_b32_dpp v19, v16 quad_perm:[3,3,3,3] row_mask:0xf bank_mask:0xf
    v_mov_b32_dpp v16, v16 quad_perm:[0,0,0,0] row_mask:0xf bank_mask:0xf
    v_cvt_pk_bf16_f32 v24, v16, v17
    v_cvt_pk_bf16_f32 v25, v18, v19
    s_mov_b64 exec, 0xffffffff
    buffer_store_dwordx4 v[24:27], v28, s[52:55], 0 offen sc1
    s_mov_b64 exec, -1
    v_mov_b32 v22, 1
    v_mov_b32 v23, 159744
    s_mov_b64 exec, 1
    ds_add_u32 v23, v22 offset:4
    s_mov_b64 exec, -1
P2_LSET:
    s_sub_u32 s23, s60, 8
    v_add_u32 v4, 0, v1
    v_mul_u32_u24 v5, 2731, v4
    v_lshrrev_b32 v5, 16, v5
    v_mul_u32_u24 v6, 24, v5
    v_sub_u32 v6, v4, v6
    v_lshrrev_b32 v7, 3, v6
    v_bfe_u32 v8, v6, 1, 2
    v_bfe_u32 v9, v5, 1, 1
    v_lshl_add_u32 v9, s23, 1, v9
    v_xor_b32 v8, v8, v9
    v_and_b32 v6, 1, v6
    v_mul_u32_u24 v10, 3072, v5
    v_lshl_add_u32 v10, v7, 10, v10
    v_lshl_add_u32 v10, v8, 5, v10
    v_lshl_add_u32 v10, v6, 4, v10
    v_add_u32 v4, 64, v1
    v_mul_u32_u24 v5, 2731, v4
    v_lshrrev_b32 v5, 16, v5
    v_mul_u32_u24 v6, 24, v5
    v_sub_u32 v6, v4, v6
    v_lshrrev_b32 v7, 3, v6
    v_bfe_u32 v8, v6, 1, 2
    v_bfe_u32 v9, v5, 1, 1
    v_lshl_add_u32 v9, s23, 1, v9
    v_xor_b32 v8, v8, v9
    v_and_b32 v6, 1, v6
    v_mul_u32_u24 v11, 3072, v5
    v_lshl_add_u32 v11, v7, 10, v11
    v_lshl_add_u32 v11, v8, 5, v11
    v_lshl_add_u32 v11, v6, 4, v11
    v_add_u32 v4, 128, v1
    v_mul_u32_u24 v5, 2731, v4
    v_lshrrev_b32 v5, 16, v5
    v_mul_u32_u24 v6, 24, v5
    v_sub_u32 v6, v4, v6
    v_lshrrev_b32 v7, 3, v6
    v_bfe_u32 v8, v6, 1, 2
    v_bfe_u32 v9, v5, 1, 1
    v_lshl_add_u32 v9, s23, 1, v9
    v_xor_b32 v8, v8, v9
    v_and_b32 v6, 1, v6
    v_mul_u32_u24 v12, 3072, v5
    v_lshl_add_u32 v12, v7, 10, v12
    v_lshl_add_u32 v12, v8, 5, v12
    v_lshl_add_u32 v12, v6, 4, v12
    s_lshl_b32 s20, s25, 7
    s_mul_i32 s21, s23, 8*3072
    s_add_u32 s20, s20, s21
    s_mul_i32 s22, s23, 3072
    s_add_u32 s22, s22, 65536
    s_mov_b32 s24, s22
    s_cmp_lt_u32 s2, 64
    s_cselect_b32 s27, 9, 8
    v_mov_b32 v23, 159748
    s_mov_b32 s95, 0x400000
LW_4:
    ds_read_b32 v22, v23 offset:0
    s_waitcnt lgkmcnt(0)
    v_cmp_eq_u32 vcc, s27, v22
    s_cbranch_vccnz LWE_5
    s_sub_u32 s95, s95, 1
    s_cmp_eq_u32 s95, 0
    s_cbranch_scc1 LWE_5
    s_sleep 1
    s_branch LW_4
LWE_5:
    v_lshrrev_b32 v14, 1, v1
    v_lshlrev_b32 v14, 7, v14
    v_and_b32 v15, 1, v1
    v_lshl_add_u32 v14, v15, 5, v14
    v_add_u32 v13, 4096, v14
    v_mov_b32 v15, 0
    v_lshlrev_b32 v22, 4, v1
    v_add_u32 v22, 157696, v22
    v_mov_b32 v23, 159744
    v_mov_b32 v18, 1
    s_and_b32 s12, s2, 7
    s_lshl_b32 s12, s12, 13
    s_add_u32 s12, s12, 327680
    s_mov_b32 s95, 0x20000
    s_and_b32 s13, s2, 63
    s_lshl_b32 s13, s13, 7
    s_add_u32 s13, s13, 393208
    s_cmp_lt_u32 s2, 64
    s_cselect_b32 s19, 2, 2
    s_cmp_eq_u32 s60, 9
    s_cselect_b32 s19, 9, s19
    s_mov_b32 s27, 4
P2_LPRE:
    s_add_u32 m0, s24, 0
    s_add_u32 s21, s20, 0
    buffer_load_dwordx4 v10, s[32:35], s21 offen lds
    s_add_u32 m0, s24, 1024
    s_nop 0
    buffer_load_dwordx4 v11, s[32:35], s21 offen lds
    s_add_u32 m0, s24, 2048
    s_nop 0
    buffer_load_dwordx4 v12, s[32:35], s21 offen lds
    s_add_u32 m0, s24, 6144
    s_add_u32 s21, s20, 49152
    buffer_load_dwordx4 v10, s[32:35], s21 offen lds
    s_add_u32 m0, s24, 7168
    s_nop 0
    buffer_load_dwordx4 v11, s[32:35], s21 offen lds
    s_add_u32 m0, s24, 8192
    s_nop 0
    buffer_load_dwordx4 v12, s[32:35], s21 offen lds
    s_add_u32 m0, s24, 12288
    s_add_u32 s21, s20, 98304
    buffer_load_dwordx4 v10, s[32:35], s21 offen lds
    s_add_u32 m0, s24, 13312
    s_nop 0
    buffer_load_dwordx4 v11, s[32:35], s21 offen lds
    s_add_u32 m0, s24, 14336
    s_nop 0
    buffer_load_dwordx4 v12, s[32:35], s21 offen lds
    s_add_u32 m0, s24, 18432
    s_add_u32 s21, s20, 147456
    buffer_load_dwordx4 v10, s[32:35], s21 offen lds
    s_add_u32 m0, s24, 19456
    s_nop 0
    buffer_load_dwordx4 v11, s[32:35], s21 offen lds
    s_add_u32 m0, s24, 20480
    s_nop 0
    buffer_load_dwordx4 v12, s[32:35], s21 offen lds
    s_add_u32 s20, s20, 196608
    s_add_u32 s24, s24, 24576
    s_sub_u32 s27, s27, 1
    s_cmp_eq_u32 s27, s19
    s_cbranch_scc0 P2_NOG
    buffer_load_dwordx2 v[16:17], v15, s[4:7], 0 offen sc1
    buffer_load_dwordx4 v[32:35], v14, s[52:55], s12 offen offset:0 sc1
    buffer_load_dwordx4 v[36:39], v14, s[52:55], s12 offen offset:16 sc1
    buffer_load_dwordx4 v[40:43], v13, s[52:55], s12 offen offset:0 sc1
    buffer_load_dwordx4 v[44:47], v13, s[52:55], s12 offen offset:16 sc1
P2_NOG:
    s_cmp_eq_u32 s27, 1
    s_cbranch_scc0 P2_LPRE2
    s_cmp_eq_u32 s60, 9
    s_cbranch_scc1 P2_W9
    buffer_load_dwordx4 v[48:51], v14, s[52:55], s12 offen offset:0 sc1
    buffer_load_dwordx4 v[52:55], v14, s[52:55], s12 offen offset:16 sc1
    buffer_load_dwordx4 v[56:59], v13, s[52:55], s12 offen offset:0 sc1
    buffer_load_dwordx4 v[60:63], v13, s[52:55], s12 offen offset:16 sc1
    s_cmp_lt_u32 s2, 64
    s_cbranch_scc1 P2_GWM
    s_waitcnt vmcnt(16)
P2_GWM:
    s_waitcnt vmcnt(16)
    s_branch P2_G0B
P2_G0:
    buffer_load_dwordx2 v[16:17], v15, s[4:7], 0 offen sc1
    s_waitcnt vmcnt(0)
P2_G0B:
    v_readfirstlane_b32 s100, v16
    v_readfirstlane_b32 s101, v17
    s_sub_u32 s95, s95, 1
    s_cbranch_scc1 P2_GN
    s_cmp_eq_u32 s101, 0
    s_cbranch_scc1 P2_G0
P2_GN:
    s_mov_b32 s95, 0x20000
    s_sub_u32 s8, s100, 1024
    s_subb_u32 s9, s101, 0
    s_add_u32 s10, s8, 0x4000000
    s_addc_u32 s11, s9, 0
    s_cmp_ge_u32 s2, 64
    s_cbranch_scc1 P2_G1A
    v_cmp_gt_u64 vcc, s[8:9], v[26:27]
    s_cbranch_vccz P2_G1A
    v_mov_b32 v26, v16
    v_mov_b32 v27, v17
    s_mov_b64 exec, 0xffffffff
    buffer_store_dwordx4 v[24:27], v28, s[52:55], 0 offen sc1
    s_mov_b64 exec, -1
P2_G1A:
    v_cmpx_le_u64 vcc, s[8:9], v[34:35]
    v_cmpx_gt_u64 vcc, s[10:11], v[34:35]
    v_cmpx_le_u64 vcc, s[8:9], v[38:39]
    v_cmpx_gt_u64 vcc, s[10:11], v[38:39]
    v_cmpx_le_u64 vcc, s[8:9], v[42:43]
    v_cmpx_gt_u64 vcc, s[10:11], v[42:43]
    v_cmpx_le_u64 vcc, s[8:9], v[46:47]
    v_cmpx_gt_u64 vcc, s[10:11], v[46:47]
    s_nop 0
    s_not_b64 exec, exec
    s_cbranch_scc0 P2_GOK
    buffer_load_dwordx4 v[32:35], v14, s[52:55], s12 offen offset:0 sc1
    buffer_load_dwordx4 v[36:39], v14, s[52:55], s12 offen offset:16 sc1
    buffer_load_dwordx4 v[40:43], v13, s[52:55], s12 offen offset:0 sc1
    buffer_load_dwordx4 v[44:47], v13, s[52:55], s12 offen offset:16 sc1
    s_mov_b64 exec, -1
    s_waitcnt vmcnt(4)
    v_cmpx_le_u64 vcc, s[8:9], v[50:51]
    v_cmpx_gt_u64 vcc, s[10:11], v[50:51]
    v_cmpx_le_u64 vcc, s[8:9], v[54:55]
    v_cmpx_gt_u64 vcc, s[10:11], v[54:55]
    v_cmpx_le_u64 vcc, s[8:9], v[58:59]
    v_cmpx_gt_u64 vcc, s[10:11], v[58:59]
    v_cmpx_le_u64 vcc, s[8:9], v[62:63]
    v_cmpx_gt_u64 vcc, s[10:11], v[62:63]
    s_nop 0
    s_not_b64 exec, exec
    s_cbranch_scc0 P2_GOY
    buffer_load_dwordx4 v[48:51], v14, s[52:55], s12 offen offset:0 sc1
    buffer_load_dwordx4 v[52:55], v14, s[52:55], s12 offen offset:16 sc1
    buffer_load_dwordx4 v[56:59], v13, s[52:55], s12 offen offset:0 sc1
    buffer_load_dwordx4 v[60:63], v13, s[52:55], s12 offen offset:16 sc1
    s_mov_b64 exec, -1
    s_waitcnt vmcnt(4)
    s_sub_u32 s95, s95, 1
    s_cbranch_scc0 P2_G1A
P2_GOY:
    s_mov_b64 exec, -1
    ds_write_b64 v22, v[48:49] offset:1024
    ds_write_b64 v22, v[52:53] offset:1032
    ds_write_b64 v22, v[56:57] offset:0
    ds_write_b64 v22, v[60:61] offset:8
    s_branch P2_GOZ
P2_GOK:
    s_mov_b64 exec, -1
    ds_write_b64 v22, v[32:33] offset:1024
    ds_write_b64 v22, v[36:37] offset:1032
    ds_write_b64 v22, v[40:41] offset:0
    ds_write_b64 v22, v[44:45] offset:8
P2_GOZ:
    ds_write_b64 v23, v[16:17] offset:8
    ds_write_b32 v23, v18
    v_readfirstlane_b32 s100, v16
    v_readfirstlane_b32 s101, v17
    s_waitcnt lgkmcnt(0)
    s_branch P2_LB0
P2_W9:
    s_cmp_lt_u32 s2, 64
    s_cbranch_scc1 P2_NOT2
    s_lshr_b32 s12, s2, 3
    s_sub_u32 s12, s12, 8
    s_mul_i32 s13, s12, 160
    s_and_b32 s14, s2, 1
    s_lshl_b32 s14, s14, 9
    s_add_u32 s14, s14, 589824
    v_min_u32 v4, 159, v1
    v_add_u32 v4, 0, v4
    v_add_u32 v4, s13, v4
    v_mul_u32_u24 v5, 5462, v4
    v_lshrrev_b32 v5, 16, v5
    v_mul_u32_u24 v6, 12, v5
    v_sub_u32 v6, v4, v6
    v_mul_u32_u24 v5, 3072, v5
    v_lshrrev_b32 v7, 2, v6
    v_lshl_add_u32 v5, v7, 10, v5
    v_and_b32 v7, 3, v6
    v_lshl_add_u32 v5, v7, 7, v5
    buffer_load_dword v36, v5, s[32:35], s14 offen
    v_min_u32 v4, 95, v1
    v_add_u32 v4, 64, v4
    v_add_u32 v4, s13, v4
    v_mul_u32_u24 v5, 5462, v4
    v_lshrrev_b32 v5, 16, v5
    v_mul_u32_u24 v6, 12, v5
    v_sub_u32 v6, v4, v6
    v_mul_u32_u24 v5, 3072, v5
    v_lshrrev_b32 v7, 2, v6
    v_lshl_add_u32 v5, v7, 10, v5
    v_and_b32 v7, 3, v6
    v_lshl_add_u32 v5, v7, 7, v5
    buffer_load_dword v37, v5, s[32:35], s14 offen
    v_min_u32 v4, 31, v1
    v_add_u32 v4, 128, v4
    v_add_u32 v4, s13, v4
    v_mul_u32_u24 v5, 5462, v4
    v_lshrrev_b32 v5, 16, v5
    v_mul_u32_u24 v6, 12, v5
    v_sub_u32 v6, v4, v6
    v_mul_u32_u24 v5, 3072, v5
    v_lshrrev_b32 v7, 2, v6
    v_lshl_add_u32 v5, v7, 10, v5
    v_and_b32 v7, 3, v6
    v_lshl_add_u32 v5, v7, 7, v5
    buffer_load_dword v38, v5, s[32:35], s14 offen
P2_NOCODE:
    s_sub_u32 s13, s2, 224
    s_cbranch_scc1 P2_NOFT
    s_lshl_b32 s13, s13, 14
    s_add_u32 s13, s13, 524288
    v_lshlrev_b32 v4, 8, v1
    buffer_load_dword v34, v4, s[52:55], s13 offen sc1
P2_NOFT:
    s_cmp_eq_u32 s12, 9
    s_cbranch_scc0 P2_NOT2
    v_lshlrev_b32 v4, 19, v1
    buffer_load_dword v35, v4, s[52:55], 0 offen sc1
    buffer_load_dword v35, v4, s[36:39], 0 offen
    buffer_load_dword v35, v4, s[40:43], 0 offen
    buffer_load_dword v35, v4, s[44:47], 0 offen
    buffer_load_dword v35, v4, s[48:51], 0 offen
    buffer_load_dword v35, v4, s[56:59], 0 offen
P2_NOT2:
    v_mov_b32 v23, 159744
    s_mov_b32 s95, 0x400000
LW_6:
    ds_read_b32 v22, v23 offset:0
    s_waitcnt lgkmcnt(0)
    v_cmp_eq_u32 vcc, 1, v22
    s_cbranch_vccnz LWE_7
    s_sub_u32 s95, s95, 1
    s_cmp_eq_u32 s95, 0
    s_cbranch_scc1 LWE_7
    s_sleep 2
    s_branch LW_6
LWE_7:
    ds_read_b64 v[16:17], v23 offset:8
    s_waitcnt lgkmcnt(0)
    v_readfirstlane_b32 s100, v16
    v_readfirstlane_b32 s101, v17
P2_LB0:
    s_waitcnt vmcnt(0)
P2_LB1:
    s_barrier
P2_LPRE2:
    s_cmp_lg_u32 s27, 0
    s_cbranch_scc1 P2_LPRE
    s_mov_b32 s24, s22
    s_mov_b32 s27, 4
P2_LMAIN:
    s_waitcnt vmcnt(24)
    s_barrier
    s_add_u32 m0, s24, 0
    s_add_u32 s21, s20, 0
    buffer_load_dwordx4 v10, s[32:35], s21 offen lds
    s_add_u32 m0, s24, 1024
    s_nop 0
    buffer_load_dwordx4 v11, s[32:35], s21 offen lds
    s_add_u32 m0, s24, 2048
    s_nop 0
    buffer_load_dwordx4 v12, s[32:35], s21 offen lds
    s_add_u32 m0, s24, 6144
    s_add_u32 s21, s20, 49152
    buffer_load_dwordx4 v10, s[32:35], s21 offen lds
    s_add_u32 m0, s24, 7168
    s_nop 0
    buffer_load_dwordx4 v11, s[32:35], s21 offen lds
    s_add_u32 m0, s24, 8192
    s_nop 0
    buffer_load_dwordx4 v12, s[32:35], s21 offen lds
    s_add_u32 m0, s24, 12288
    s_add_u32 s21, s20, 98304
    buffer_load_dwordx4 v10, s[32:35], s21 offen lds
    s_add_u32 m0, s24, 13312
    s_nop 0
    buffer_load_dwordx4 v11, s[32:35], s21 offen lds
    s_add_u32 m0, s24, 14336
    s_nop 0
    buffer_load_dwordx4 v12, s[32:35], s21 offen lds
    s_add_u32 m0, s24, 18432
    s_add_u32 s21, s20, 147456
    buffer_load_dwordx4 v10, s[32:35], s21 offen lds
    s_add_u32 m0, s24, 19456
    s_nop 0
    buffer_load_dwordx4 v11, s[32:35], s21 offen lds
    s_add_u32 m0, s24, 20480
    s_nop 0
    buffer_load_dwordx4 v12, s[32:35], s21 offen lds
    s_add_u32 s20, s20, 196608
    s_add_u32 s24, s24, 24576
    s_sub_u32 s27, s27, 1
    s_cmp_lg_u32 s27, 0
    s_cbranch_scc1 P2_LMAIN
    s_waitcnt vmcnt(24)
    s_barrier
    s_waitcnt vmcnt(12)
    s_barrier
    s_waitcnt vmcnt(0)
    s_barrier
    s_setprio 3
    s_lshl_b32 s20, s25, 7
    s_lshl_b32 s21, s26, 2
    s_add_u32 s20, s20, s21
    s_add_u32 s20, s20, 0
    s_lshl_b32 s20, s20, 6
    s_add_u32 s20, s20, 524288
    v_mov_b32 v4, s100
    v_mov_b32 v5, s101
    v_lshlrev_b32 v6, 19, v1
    s_cmp_eq_u32 s60, 8
    s_cselect_b64 exec, 1, 0
    s_barrier
    buffer_store_dwordx2 v[4:5], v6, s[52:55], s20 offen sc1
    s_mov_b64 exec, -1
P2_END:
    s_and_b32 s25, s2, 7
    s_lshl_b32 s25, s25, 2
    s_bfe_u32 s26, s2, 0x20003
    s_add_u32 s25, s25, s26
    s_lshr_b32 s26, s2, 5
    s_lshl_b32 s27, s25, 16
    v_lshlrev_b32 v4, 4, v1
    s_cmp_ge_u32 s60, 8
    s_cbranch_scc1 P3_LOADER
    v_lshrrev_b32 v3, 5, v1
    v_and_b32 v5, 15, v1
    v_lshlrev_b32 v5, 4, v5
    v_lshl_add_u32 v5, v3, 8, v5
    s_mov_b32 s4, 0x0000ffff
    s_mov_b32 s5, 0x0000ffff
    s_and_b32 s8, s60, 3
    s_lshr_b32 s9, s60, 2
    s_lshl_b32 s10, s26, 18
    s_lshl_b32 s11, s8, 16
    s_add_u32 s10, s10, s11
    s_lshl_b32 s11, s25, 10
    s_add_u32 s10, s10, s11
    s_add_u32 s10, s10, 7340032
    s_add_u32 s11, s10, 32768
    s_mul_i32 s12, s9, 57344
    v_add_u32 v6, s12, v4
    v_add_u32 v7, s12, v5
    v_add_u32 v7, 65536, v7
    s_lshl_b32 s12, s8, 11
    s_add_u32 s12, s12, 131072
    v_add_u32 v2, s12, v4
    s_cmp_eq_u32 s9, 0
    s_cselect_b32 s6, 3, 1
    s_cselect_b32 s15, 13, 3
    s_cselect_b32 s18, 3, 1
    s_bfe_u32 s19, s2, 0x30003
    s_lshl_b32 s19, s19, 7
    s_and_b32 s23, s8, 1
    s_lshr_b32 s24, s8, 1
    s_lshl_b32 s12, s24, 6
    s_add_u32 s19, s19, s12
    s_lshl_b32 s12, s23, 15
    s_add_u32 s19, s19, s12
    s_and_b32 s12, s2, 7
    s_lshl_b32 s12, s12, 18
    s_add_u32 s19, s19, s12
    s_lshr_b32 s12, s2, 6
    s_lshl_b32 s12, s12, 16
    s_add_u32 s19, s19, s12
    s_mov_b32 s7, 0
    v_and_b32 v3, 27, v1
    v_cmp_eq_u32 vcc, 16, v3
    v_mov_b32 v3, 0x3f803f80
    s_nop 0
    v_cndmask_b32 v136, 0, v3, vcc
    v_mov_b32 v137, v136
    v_mov_b32 v138, v136
    v_mov_b32 v139, v136
    v_mov_b32 v140, v136
    v_mov_b32 v141, v136
    v_mov_b32 v142, v136
    v_mov_b32 v143, v136
    v_mov_b32 v144, v136
    v_mov_b32 v145, v136
    v_mov_b32 v146, v136
    v_mov_b32 v147, v136
    v_mov_b32 v148, v136
    v_mov_b32 v149, v136
    v_mov_b32 v150, v136
    v_mov_b32 v151, v136
    v_mov_b32 v96, 0
    v_mov_b32 v97, 0
    v_mov_b32 v98, 0
    v_mov_b32 v99, 0
    v_mov_b32 v100, 0
    v_mov_b32 v101, 0
    v_mov_b32 v102, 0
    v_mov_b32 v103, 0
    v_mov_b32 v104, 0
    v_mov_b32 v105, 0
    v_mov_b32 v106, 0
    v_mov_b32 v107, 0
    v_mov_b32 v108, 0
    v_mov_b32 v109, 0
    v_mov_b32 v110, 0
    v_mov_b32 v111, 0
    v_mov_b32 v112, 0
    v_mov_b32 v113, 0
    v_mov_b32 v114, 0
    v_mov_b32 v115, 0
    v_mov_b32 v116, 0
    v_mov_b32 v117, 0
    v_mov_b32 v118, 0
    v_mov_b32 v119, 0
    v_mov_b32 v120, 0
    v_mov_b32 v121, 0
    v_mov_b32 v122, 0
    v_mov_b32 v123, 0
    v_mov_b32 v124, 0
    v_mov_b32 v125, 0
    v_mov_b32 v126, 0
    v_mov_b32 v127, 0
    v_mov_b32 v88, 0
    v_mov_b32 v89, 0
    v_mov_b32 v90, 0
    v_mov_b32 v91, 0
    v_mov_b32 v92, 0
    v_mov_b32 v93, 0
    v_mov_b32 v94, 0
    v_mov_b32 v95, 0
    v_lshlrev_b32 v154, 2, v1
    v_add_u32 v152, 161792, v154
    ds_write_b32 v152, v88
    s_lshl_b32 s12, s8, 2
    s_add_u32 s12, s12, 161792
    v_mov_b32 v152, s12
    s_mul_i32 s12, s8, 4608
    s_add_u32 s12, s12, 131072
    v_add_u32 v153, s12, v4
    v_add_u32 v154, s12, v154
    v_mov_b32 v155, 1
    v_and_b32 v3, 31, v1
    v_lshrrev_b32 v8, 5, v1
    v_lshlrev_b32 v3, 10, v3
    v_lshl_add_u32 v3, v8, 3, v3
    v_mov_b32 v0, 161792
    v_mov_b32 v8, 161040
    v_mov_b32 v9, 161024
    v_cndmask_b32 v8, v8, v9, vcc
    v_mov_b32 v156, 0x800
    s_not_b64 exec, s[4:5]
    v_mov_b32 v7, v8
    v_mov_b32 v156, 0
    s_mov_b64 exec, 0x00330000
    v_and_b32 v9, 4, v1
    v_lshl_add_u32 v9, v9, 7, v8
    ds_write_b128 v9, v[136:139] offset:1024
    ds_write_b128 v9, v[136:139] offset:2048
    s_mov_b64 exec, -1
    s_setprio 1
    s_waitcnt lgkmcnt(0)
    s_barrier
    ds_read_b128 v[80:83], v4
    ds_read_b128 v[8:11], v2
    ds_read_b128 v[12:15], v2 offset:1024
    ds_read_b128 v[128:131], v6
    ds_read_b128 v[132:135], v6 offset:1024
    s_mov_b64 exec, s[4:5]
    ds_read_b128 v[136:139], v7
    ds_read_b128 v[140:143], v7 offset:512
    s_mov_b64 exec, -1
    s_waitcnt lgkmcnt(5)
    v_mfma_f32_32x32x16_bf16 v[48:63], v[80:83], v[8:11], 0
    s_waitcnt lgkmcnt(4)
    v_mfma_f32_32x32x16_bf16 v[64:79], v[80:83], v[12:15], 0
    s_nop 9
    v_max3_f32 v16, v48, v49, v50
    v_max3_f32 v16, v16, v51, v52
    v_max3_f32 v16, v16, v53, v54
    v_max3_f32 v16, v16, v55, v56
    v_max3_f32 v16, v16, v57, v58
    v_max3_f32 v16, v16, v59, v60
    v_max3_f32 v16, v16, v61, v62
    v_max_f32 v16, v16, v63
    v_max3_f32 v32, v64, v65, v66
    v_max3_f32 v32, v32, v67, v68
    v_max3_f32 v32, v32, v69, v70
    v_max3_f32 v32, v32, v71, v72
    v_max3_f32 v32, v32, v73, v74
    v_max3_f32 v32, v32, v75, v76
    v_max3_f32 v32, v32, v77, v78
    v_max_f32 v32, v32, v79
    v_mov_b32 v17, v16
    v_mov_b32 v33, v32
    s_nop 0
    v_permlane32_swap_b32 v16, v17
    v_permlane32_swap_b32 v32, v33
    v_min_f32_e64 v16, -v16, -v17
    v_min_f32_e64 v32, -v32, -v33
    v_mov_b32 v17, v16
    v_mov_b32 v33, v32
    v_pk_mov_b32 v[18:19], v[16:17], v[16:17]
    v_pk_mov_b32 v[20:21], v[16:17], v[16:17]
    v_pk_mov_b32 v[22:23], v[16:17], v[16:17]
    v_pk_mov_b32 v[24:25], v[16:17], v[16:17]
    v_pk_mov_b32 v[26:27], v[16:17], v[16:17]
    v_pk_mov_b32 v[28:29], v[16:17], v[16:17]
    v_pk_mov_b32 v[30:31], v[16:17], v[16:17]
    s_waitcnt lgkmcnt(0)
    s_nop 0
    v_mfma_f32_32x32x16_bf16 v[48:63], v[128:131], v[8:11], v[16:31]
    v_pk_mov_b32 v[34:35], v[32:33], v[32:33]
    v_pk_mov_b32 v[36:37], v[32:33], v[32:33]
    v_pk_mov_b32 v[38:39], v[32:33], v[32:33]
    v_pk_mov_b32 v[40:41], v[32:33], v[32:33]
    v_pk_mov_b32 v[42:43], v[32:33], v[32:33]
    v_pk_mov_b32 v[44:45], v[32:33], v[32:33]
    v_pk_mov_b32 v[46:47], v[32:33], v[32:33]
    s_barrier
    s_nop 5
.p2align 6
P3_LOOP:
    v_exp_f32 v48, v48
    v_exp_f32 v49, v49
    v_exp_f32 v50, v50
    v_exp_f32 v51, v51
    v_exp_f32 v52, v52
    v_cvt_pk_bf16_f32 v80, v48, v49
    v_mfma_f32_32x32x16_bf16 v[64:79], v[128:131], v[12:15], v[32:47]
    ds_read_b128 v[128:131], v6 offset:2048
    v_cvt_pk_bf16_f32 v81, v50, v51
    v_exp_f32 v53, v53
    v_exp_f32 v54, v54
    v_exp_f32 v55, v55
    v_exp_f32 v56, v56
    v_exp_f32 v57, v57
    v_cvt_pk_bf16_f32 v82, v52, v53
    v_mfma_f32_32x32x16_bf16 v[112:127], v[144:147], v[88:91], v[112:127]
    ds_read_b128 v[144:147], v7 offset:1024
    v_cvt_pk_bf16_f32 v83, v54, v55
    v_exp_f32 v58, v58
    v_exp_f32 v59, v59
    v_exp_f32 v60, v60
    v_exp_f32 v61, v61
    v_exp_f32 v62, v62
    v_exp_f32 v63, v63
    v_cvt_pk_bf16_f32 v84, v56, v57
    v_mfma_f32_32x32x16_bf16 v[112:127], v[148:151], v[92:95], v[112:127]
    ds_read_b128 v[148:151], v7 offset:1536
    v_cvt_pk_bf16_f32 v85, v58, v59
    v_cvt_pk_bf16_f32 v86, v60, v61
    v_cvt_pk_bf16_f32 v87, v62, v63
    v_exp_f32 v64, v64
    v_exp_f32 v65, v65
    v_exp_f32 v66, v66
    v_exp_f32 v67, v67
    v_exp_f32 v68, v68
    v_cvt_pk_bf16_f32 v88, v64, v65
    v_mfma_f32_32x32x16_bf16 v[48:63], v[132:135], v[8:11], v[16:31]
    s_sub_u32 s6, s6, 1
    v_cvt_pk_bf16_f32 v89, v66, v67
    v_exp_f32 v69, v69
    v_exp_f32 v70, v70
    v_exp_f32 v71, v71
    v_exp_f32 v72, v72
    v_exp_f32 v73, v73
    v_cvt_pk_bf16_f32 v90, v68, v69
    v_mfma_f32_32x32x16_bf16 v[96:111], v[136:139], v[80:83], v[96:111]
    s_cmp_lg_u32 s6, 0
    v_cvt_pk_bf16_f32 v91, v70, v71
    v_exp_f32 v74, v74
    v_exp_f32 v75, v75
    v_exp_f32 v76, v76
    v_exp_f32 v77, v77
    v_exp_f32 v78, v78
    v_exp_f32 v79, v79
    v_cvt_pk_bf16_f32 v92, v72, v73
    v_mfma_f32_32x32x16_bf16 v[96:111], v[140:143], v[84:87], v[96:111]
    s_waitcnt lgkmcnt(0)
    v_cvt_pk_bf16_f32 v93, v74, v75
    v_cvt_pk_bf16_f32 v94, v76, v77
    v_cvt_pk_bf16_f32 v95, v78, v79
    v_exp_f32 v48, v48
    v_exp_f32 v49, v49
    v_exp_f32 v50, v50
    v_exp_f32 v51, v51
    v_exp_f32 v52, v52
    v_cvt_pk_bf16_f32 v80, v48, v49
    v_mfma_f32_32x32x16_bf16 v[64:79], v[132:135], v[12:15], v[32:47]
    ds_read_b128 v[132:135], v6 offset:3072
    v_cvt_pk_bf16_f32 v81, v50, v51
    v_exp_f32 v53, v53
    v_exp_f32 v54, v54
    v_exp_f32 v55, v55
    v_exp_f32 v56, v56
    v_exp_f32 v57, v57
    v_cvt_pk_bf16_f32 v82, v52, v53
    v_mfma_f32_32x32x16_bf16 v[112:127], v[136:139], v[88:91], v[112:127]
    ds_read_b128 v[136:139], v7 offset:2048
    v_cvt_pk_bf16_f32 v83, v54, v55
    v_exp_f32 v58, v58
    v_exp_f32 v59, v59
    v_exp_f32 v60, v60
    v_exp_f32 v61, v61
    v_exp_f32 v62, v62
    v_exp_f32 v63, v63
    v_cvt_pk_bf16_f32 v84, v56, v57
    v_mfma_f32_32x32x16_bf16 v[112:127], v[140:143], v[92:95], v[112:127]
    ds_read_b128 v[140:143], v7 offset:2560
    v_cvt_pk_bf16_f32 v85, v58, v59
    v_cvt_pk_bf16_f32 v86, v60, v61
    v_cvt_pk_bf16_f32 v87, v62, v63
    v_exp_f32 v64, v64
    v_exp_f32 v65, v65
    v_exp_f32 v66, v66
    v_exp_f32 v67, v67
    v_exp_f32 v68, v68
    v_cvt_pk_bf16_f32 v88, v64, v65
    v_mfma_f32_32x32x16_bf16 v[48:63], v[128:131], v[8:11], v[16:31]
    v_add_u32 v6, 0x800, v6
    v_cvt_pk_bf16_f32 v89, v66, v67
    v_exp_f32 v69, v69
    v_exp_f32 v70, v70
    v_exp_f32 v71, v71
    v_exp_f32 v72, v72
    v_exp_f32 v73, v73
    v_cvt_pk_bf16_f32 v90, v68, v69
    v_mfma_f32_32x32x16_bf16 v[96:111], v[144:147], v[80:83], v[96:111]
    v_add_u32 v7, v156, v7
    v_cvt_pk_bf16_f32 v91, v70, v71
    v_exp_f32 v74, v74
    v_exp_f32 v75, v75
    v_exp_f32 v76, v76
    v_exp_f32 v77, v77
    v_exp_f32 v78, v78
    v_exp_f32 v79, v79
    v_cvt_pk_bf16_f32 v92, v72, v73
    v_mfma_f32_32x32x16_bf16 v[96:111], v[148:151], v[84:87], v[96:111]
    s_waitcnt lgkmcnt(0)
    v_cvt_pk_bf16_f32 v93, v74, v75
    v_cvt_pk_bf16_f32 v94, v76, v77
    v_cvt_pk_bf16_f32 v95, v78, v79
    s_cbranch_scc1 P3_LOOP
    s_cmp_eq_u32 s7, 1
    s_cbranch_scc1 P3_DONE
    s_cmp_eq_u32 s7, 0
    s_cbranch_scc0 P3_SEG3
    s_barrier
    s_mov_b32 s7, s18
    s_mov_b32 s6, s15
    s_branch P3_LOOP
P3_SEG3:
    s_cmp_eq_u32 s7, 4
    s_cbranch_scc1 P3_SEG4
    buffer_load_dwordx2 v[160:161], v3, s[28:31], s19 offen offset:0
    buffer_load_dwordx2 v[162:163], v3, s[28:31], s19 offen offset:16
    buffer_load_dwordx2 v[164:165], v3, s[28:31], s19 offen offset:32
    buffer_load_dwordx2 v[166:167], v3, s[28:31], s19 offen offset:48
    s_mov_b64 exec, 1
    ds_add_u32 v0, v155 offset:16
    s_mov_b64 exec, -1
    s_mov_b32 s7, 4
    s_mov_b32 s6, 8
    s_branch P3_LOOP
P3_SEG4:
    ds_write_b32 v152, v155 offset:32
    s_mov_b32 s7, 1
    s_mov_b32 s6, 4
    s_branch P3_LOOP
    s_mov_b32 s7, 1
    s_mov_b32 s6, 12
    s_branch P3_LOOP
P3_DONE:
    s_nop 1
    v_mfma_f32_32x32x16_bf16 v[112:127], v[144:147], v[88:91], v[112:127]
    v_mfma_f32_32x32x16_bf16 v[112:127], v[148:151], v[92:95], v[112:127]
    s_cmp_eq_u32 s9, 0
    s_cbranch_scc0 P3_WAITP
    s_nop 7
    ds_write_b128 v153, v[96:99] offset:0
    ds_write_b128 v153, v[100:103] offset:1024
    ds_write_b32 v154, v104 offset:4096
    ds_write_b128 v153, v[112:115] offset:2048
    ds_write_b128 v153, v[116:119] offset:3072
    ds_write_b32 v154, v120 offset:4352
    ds_write_b32 v152, v155
    s_branch P3_END
P3_WAITP:
    s_mov_b32 s95, 0x400000
P3_PW:
    ds_read_b32 v156, v152
    ds_read_b128 v[48:51], v153 offset:0
    ds_read_b128 v[52:55], v153 offset:1024
    ds_read_b32 v56, v154 offset:4096
    ds_read_b128 v[64:67], v153 offset:2048
    ds_read_b128 v[68:71], v153 offset:3072
    ds_read_b32 v72, v154 offset:4352
    s_sub_u32 s95, s95, 1
    s_cbranch_scc1 P3_PWOK
    s_waitcnt lgkmcnt(6)
    v_cmp_eq_u32 vcc, 1, v156
    s_cbranch_vccnz P3_PWOK
    s_waitcnt lgkmcnt(0)
    s_sleep 2
    s_branch P3_PW
P3_PWOK:
    s_waitcnt lgkmcnt(3)
    v_add_f32 v104, v104, v56
    v_pk_add_f32 v[96:97], v[96:97], v[48:49]
    v_pk_add_f32 v[98:99], v[98:99], v[50:51]
    v_pk_add_f32 v[100:101], v[100:101], v[52:53]
    v_pk_add_f32 v[102:103], v[102:103], v[54:55]
    s_waitcnt lgkmcnt(0)
    v_add_f32 v120, v120, v72
    v_pk_add_f32 v[112:113], v[112:113], v[64:65]
    v_pk_add_f32 v[114:115], v[114:115], v[66:67]
    v_pk_add_f32 v[116:117], v[116:117], v[68:69]
    v_pk_add_f32 v[118:119], v[118:119], v[70:71]
P3_FINAL2:
    v_rcp_f32 v56, v104
    v_rcp_f32 v72, v120
    v_pk_mul_f32 v[48:49], v[96:97], v[56:57] op_sel_hi:[1,0]
    v_pk_mul_f32 v[50:51], v[98:99], v[56:57] op_sel_hi:[1,0]
    v_pk_mul_f32 v[52:53], v[100:101], v[56:57] op_sel_hi:[1,0]
    v_pk_mul_f32 v[54:55], v[102:103], v[56:57] op_sel_hi:[1,0]
    v_cvt_pk_bf16_f32 v80, v48, v49
    v_cvt_pk_bf16_f32 v81, v50, v51
    v_cvt_pk_bf16_f32 v82, v52, v53
    v_cvt_pk_bf16_f32 v83, v54, v55
    buffer_store_dwordx4 v[80:83], v4, s[52:55], s10 offen sc1
    v_pk_mul_f32 v[64:65], v[112:113], v[72:73] op_sel_hi:[1,0]
    v_pk_mul_f32 v[66:67], v[114:115], v[72:73] op_sel_hi:[1,0]
    v_pk_mul_f32 v[68:69], v[116:117], v[72:73] op_sel_hi:[1,0]
    v_pk_mul_f32 v[70:71], v[118:119], v[72:73] op_sel_hi:[1,0]
    v_cvt_pk_bf16_f32 v88, v64, v65
    v_cvt_pk_bf16_f32 v89, v66, v67
    v_cvt_pk_bf16_f32 v90, v68, v69
    v_cvt_pk_bf16_f32 v91, v70, v71
    buffer_store_dwordx4 v[88:91], v4, s[52:55], s11 offen sc1
    s_cmp_eq_u32 s7, 1
    s_cbranch_scc0 P3_CHECKED
    s_mov_b32 s12, 0x71800000
    s_mov_b32 s13, 0x21800000
    s_mov_b32 s14, 0x7e000000
    v_add_f32_e64 v48, abs(v96), abs(v97)
    v_add_f32_e64 v49, abs(v98), abs(v99)
    v_add_f32_e64 v48, v48, abs(v100)
    v_add_f32_e64 v49, v49, abs(v101)
    v_add_f32_e64 v48, v48, abs(v102)
    v_add_f32_e64 v49, v49, abs(v103)
    v_add_f32_e64 v64, abs(v112), abs(v113)
    v_add_f32_e64 v65, abs(v114), abs(v115)
    v_add_f32_e64 v64, v64, abs(v116)
    v_add_f32_e64 v65, v65, abs(v117)
    v_add_f32_e64 v64, v64, abs(v118)
    v_add_f32_e64 v65, v65, abs(v119)
    v_pk_add_f32 v[48:49], v[48:49], v[64:65]
    v_add_f32 v50, v104, v120
    v_min_f32 v51, v104, v120
    v_add_f32 v48, v48, v49
    v_cmp_gt_f32 vcc, s12, v50
    v_cmp_lt_f32 s[16:17], s13, v51
    v_cmp_gt_f32 s[20:21], s14, v48
    s_and_b64 vcc, vcc, s[16:17]
    s_and_b64 vcc, vcc, s[20:21]
    s_cmp_eq_u64 vcc, -1
    s_cbranch_scc0 P3_FALLBACK
P3_CHECKED:
    s_setprio 1
    s_waitcnt vmcnt(0) lgkmcnt(0)
    s_barrier
    s_branch P3_END
P3_FALLBACK:
    s_waitcnt vmcnt(0)
    s_mov_b32 s7, 2
    s_add_u32 s12, s27, 3145728
    s_add_u32 s13, s27, 5242880
    s_mov_b32 s6, 64
    v_mov_b32 v16, 0xff800000
    v_mov_b32 v32, 0xff800000
P3_FB1:
    buffer_load_dwordx4 v[128:131], v4, s[52:55], s12 offen sc1
    s_waitcnt vmcnt(0)
    v_mfma_f32_32x32x16_bf16 v[48:63], v[128:131], v[8:11], 0
    v_mfma_f32_32x32x16_bf16 v[64:79], v[128:131], v[12:15], 0
    s_nop 10
    v_max3_f32 v16, v16, v48, v49
    v_max3_f32 v16, v16, v50, v51
    v_max3_f32 v16, v16, v52, v53
    v_max3_f32 v16, v16, v54, v55
    v_max3_f32 v16, v16, v56, v57
    v_max3_f32 v16, v16, v58, v59
    v_max3_f32 v16, v16, v60, v61
    v_max3_f32 v16, v16, v62, v63
    v_max3_f32 v32, v32, v64, v65
    v_max3_f32 v32, v32, v66, v67
    v_max3_f32 v32, v32, v68, v69
    v_max3_f32 v32, v32, v70, v71
    v_max3_f32 v32, v32, v72, v73
    v_max3_f32 v32, v32, v74, v75
    v_max3_f32 v32, v32, v76, v77
    v_max3_f32 v32, v32, v78, v79
    s_add_u32 s12, s12, 1024
    s_sub_u32 s6, s6, 1
    s_cmp_lg_u32 s6, 0
    s_cbranch_scc1 P3_FB1
    v_mov_b32 v17, v16
    v_mov_b32 v33, v32
    s_nop 0
    v_permlane32_swap_b32 v16, v17
    v_permlane32_swap_b32 v32, v33
    v_min_f32_e64 v16, -v16, -v17
    v_min_f32_e64 v32, -v32, -v33
    v_mov_b32 v17, v16
    v_mov_b32 v33, v32
    v_mov_b32 v18, v16
    v_mov_b32 v19, v16
    v_mov_b32 v20, v16
    v_mov_b32 v21, v16
    v_mov_b32 v22, v16
    v_mov_b32 v23, v16
    v_mov_b32 v24, v16
    v_mov_b32 v25, v16
    v_mov_b32 v26, v16
    v_mov_b32 v27, v16
    v_mov_b32 v28, v16
    v_mov_b32 v29, v16
    v_mov_b32 v30, v16
    v_mov_b32 v31, v16
    v_mov_b32 v34, v32
    v_mov_b32 v35, v32
    v_mov_b32 v36, v32
    v_mov_b32 v37, v32
    v_mov_b32 v38, v32
    v_mov_b32 v39, v32
    v_mov_b32 v40, v32
    v_mov_b32 v41, v32
    v_mov_b32 v42, v32
    v_mov_b32 v43, v32
    v_mov_b32 v44, v32
    v_mov_b32 v45, v32
    v_mov_b32 v46, v32
    v_mov_b32 v47, v32
    v_mov_b32 v96, 0
    v_mov_b32 v97, 0
    v_mov_b32 v98, 0
    v_mov_b32 v99, 0
    v_mov_b32 v100, 0
    v_mov_b32 v101, 0
    v_mov_b32 v102, 0
    v_mov_b32 v103, 0
    v_mov_b32 v104, 0
    v_mov_b32 v105, 0
    v_mov_b32 v106, 0
    v_mov_b32 v107, 0
    v_mov_b32 v108, 0
    v_mov_b32 v109, 0
    v_mov_b32 v110, 0
    v_mov_b32 v111, 0
    v_mov_b32 v112, 0
    v_mov_b32 v113, 0
    v_mov_b32 v114, 0
    v_mov_b32 v115, 0
    v_mov_b32 v116, 0
    v_mov_b32 v117, 0
    v_mov_b32 v118, 0
    v_mov_b32 v119, 0
    v_mov_b32 v120, 0
    v_mov_b32 v121, 0
    v_mov_b32 v122, 0
    v_mov_b32 v123, 0
    v_mov_b32 v124, 0
    v_mov_b32 v125, 0
    v_mov_b32 v126, 0
    v_mov_b32 v127, 0
    s_add_u32 s12, s27, 3145728
    s_mov_b32 s6, 64
P3_FB2:
    buffer_load_dwordx4 v[128:131], v4, s[52:55], s12 offen sc1
    s_mov_b64 exec, s[4:5]
    buffer_load_dwordx4 v[136:139], v5, s[52:55], s13 offen sc1
    buffer_load_dwordx4 v[140:143], v5, s[52:55], s13 offen offset:512 sc1
    s_mov_b64 exec, -1
    s_waitcnt vmcnt(0)
    v_mfma_f32_32x32x16_bf16 v[48:63], v[128:131], v[8:11], v[16:31]
    v_mfma_f32_32x32x16_bf16 v[64:79], v[128:131], v[12:15], v[32:47]
    s_nop 10
    v_exp_f32 v48, v48
    v_exp_f32 v49, v49
    v_exp_f32 v50, v50
    v_exp_f32 v51, v51
    v_exp_f32 v52, v52
    v_exp_f32 v53, v53
    v_exp_f32 v54, v54
    v_exp_f32 v55, v55
    v_exp_f32 v56, v56
    v_exp_f32 v57, v57
    v_exp_f32 v58, v58
    v_exp_f32 v59, v59
    v_exp_f32 v60, v60
    v_exp_f32 v61, v61
    v_exp_f32 v62, v62
    v_exp_f32 v63, v63
    v_cvt_pk_bf16_f32 v80, v48, v49
    v_cvt_pk_bf16_f32 v81, v50, v51
    v_cvt_pk_bf16_f32 v82, v52, v53
    v_cvt_pk_bf16_f32 v83, v54, v55
    v_cvt_pk_bf16_f32 v84, v56, v57
    v_cvt_pk_bf16_f32 v85, v58, v59
    v_cvt_pk_bf16_f32 v86, v60, v61
    v_cvt_pk_bf16_f32 v87, v62, v63
    v_mfma_f32_32x32x16_bf16 v[96:111], v[136:139], v[80:83], v[96:111]
    s_nop 0
    v_mfma_f32_32x32x16_bf16 v[96:111], v[140:143], v[84:87], v[96:111]
    v_exp_f32 v64, v64
    v_exp_f32 v65, v65
    v_exp_f32 v66, v66
    v_exp_f32 v67, v67
    v_exp_f32 v68, v68
    v_exp_f32 v69, v69
    v_exp_f32 v70, v70
    v_exp_f32 v71, v71
    v_exp_f32 v72, v72
    v_exp_f32 v73, v73
    v_exp_f32 v74, v74
    v_exp_f32 v75, v75
    v_exp_f32 v76, v76
    v_exp_f32 v77, v77
    v_exp_f32 v78, v78
    v_exp_f32 v79, v79
    v_cvt_pk_bf16_f32 v88, v64, v65
    v_cvt_pk_bf16_f32 v89, v66, v67
    v_cvt_pk_bf16_f32 v90, v68, v69
    v_cvt_pk_bf16_f32 v91, v70, v71
    v_cvt_pk_bf16_f32 v92, v72, v73
    v_cvt_pk_bf16_f32 v93, v74, v75
    v_cvt_pk_bf16_f32 v94, v76, v77
    v_cvt_pk_bf16_f32 v95, v78, v79
    v_mfma_f32_32x32x16_bf16 v[112:127], v[136:139], v[88:91], v[112:127]
    s_nop 0
    v_mfma_f32_32x32x16_bf16 v[112:127], v[140:143], v[92:95], v[112:127]
    s_nop 15
    s_add_u32 s12, s12, 1024
    s_add_u32 s13, s13, 1024
    s_sub_u32 s6, s6, 1
    s_cmp_lg_u32 s6, 0
    s_cbranch_scc1 P3_FB2
    s_nop 7
    s_branch P3_FINAL2
P3_X:
    s_waitcnt vmcnt(0)
    v_readfirstlane_b32 s100, v28
    v_readfirstlane_b32 s101, v29
    s_cmp_eq_u32 s60, 10
    s_cbranch_scc0 P3_X11
    s_cmp_ge_u32 s2, 224
    s_cbranch_scc1 P3_XB3
    s_waitcnt vmcnt(6)
    ds_write_b128 v13, v[32:35] offset:0
    ds_write_b128 v13, v[36:39] offset:1024
    ds_read_b64_tr_b16 v[64:65], v14 offset:0
    ds_read_b64_tr_b16 v[66:67], v14 offset:512
    ds_read_b64_tr_b16 v[80:81], v15 offset:0
    ds_read_b64_tr_b16 v[82:83], v15 offset:512
    s_waitcnt vmcnt(4)
    ds_write_b128 v13, v[40:43] offset:0
    ds_write_b128 v13, v[44:47] offset:1024
    ds_read_b64_tr_b16 v[68:69], v14 offset:0
    ds_read_b64_tr_b16 v[70:71], v14 offset:512
    ds_read_b64_tr_b16 v[84:85], v15 offset:0
    ds_read_b64_tr_b16 v[86:87], v15 offset:512
    s_waitcnt vmcnt(2) lgkmcnt(6)
    ds_write_b128 v13, v[48:51] offset:0
    ds_write_b128 v13, v[52:55] offset:1024
    ds_read_b64_tr_b16 v[72:73], v14 offset:0
    ds_read_b64_tr_b16 v[74:75], v14 offset:512
    ds_read_b64_tr_b16 v[88:89], v15 offset:0
    ds_read_b64_tr_b16 v[90:91], v15 offset:512
    s_waitcnt vmcnt(0) lgkmcnt(6)
    ds_write_b128 v13, v[56:59] offset:0
    ds_write_b128 v13, v[60:63] offset:1024
    ds_read_b64_tr_b16 v[76:77], v14 offset:0
    ds_read_b64_tr_b16 v[78:79], v14 offset:512
    ds_read_b64_tr_b16 v[92:93], v15 offset:0
    ds_read_b64_tr_b16 v[94:95], v15 offset:512
    s_waitcnt lgkmcnt(0)
    v_lshlrev_b32 v22, 8, v1
    v_lshlrev_b32 v23, 3, v1
    v_mov_b32 v24, 0x7ff00000
    v_and_b32 v25, 15, v1
    v_lshrrev_b32 v26, 4, v1
    v_lshlrev_b32 v27, 10, v25
    v_lshl_add_u32 v27, v26, 4, v27
    v_add_u32 v27, 61440, v27
    v_cmp_gt_u32 vcc, 2, v25
    s_nop 1
    v_cndmask_b32 v21, v24, v27, vcc
    v_lshrrev_b32 v9, 1, v1
    v_mul_u32_u24 v9, 3584, v9
    v_and_b32 v10, 1, v1
    v_lshl_add_u32 v9, v10, 4, v9
    v_lshrrev_b32 v11, 4, v1
    v_bfe_u32 v13, v1, 2, 3
    v_lshrrev_b32 v11, 5, v1
    v_lshl_add_u32 v13, v11, 4, v13
    v_lshlrev_b32 v13, 5, v13
    v_and_b32 v14, 3, v1
    v_lshl_add_u32 v13, v14, 3, v13
    v_add_u32 v13, 157696, v13
    v_mov_b32 v16, 0
    v_mov_b32 v17, 0
    v_mov_b32 v18, 0
    v_mov_b32 v19, 0
    s_barrier
    s_barrier
    s_barrier
    buffer_store_dwordx4 v[64:67], v4, s[52:55], s17 offen offset:0 sc1
    buffer_store_dwordx4 v[68:71], v4, s[52:55], s17 offen offset:1024 sc1
    buffer_store_dwordx4 v[72:75], v4, s[52:55], s17 offen offset:2048 sc1
    buffer_store_dwordx4 v[76:79], v4, s[52:55], s17 offen offset:3072 sc1
    buffer_store_dwordx4 v[80:83], v4, s[52:55], s18 offen offset:0 sc1
    buffer_store_dwordx4 v[84:87], v4, s[52:55], s18 offen offset:1024 sc1
    buffer_store_dwordx4 v[88:91], v4, s[52:55], s18 offen offset:2048 sc1
    buffer_store_dwordx4 v[92:95], v4, s[52:55], s18 offen offset:3072 sc1
    s_setprio 2
    s_waitcnt vmcnt(0)
    s_lshl_b32 s19, s19, 6
    s_add_u32 s19, s19, 524288
    v_mov_b32 v6, s100
    v_mov_b32 v7, s101
    v_lshlrev_b32 v8, 19, v1
    s_mov_b64 exec, 1
    buffer_store_dwordx2 v[6:7], v8, s[52:55], s19 offen sc1
    s_mov_b64 exec, -1
    s_branch P3_EXT
P3_X11:
    s_cmp_ge_u32 s2, 128
    s_cbranch_scc1 P3_XB3
    v_lshlrev_b32 v100, 16, v96
    v_and_b32 v101, 0xffff0000, v96
    v_lshlrev_b32 v102, 16, v97
    v_and_b32 v103, 0xffff0000, v97
    v_lshlrev_b32 v104, 16, v98
    v_and_b32 v105, 0xffff0000, v98
    v_lshlrev_b32 v106, 16, v99
    v_and_b32 v107, 0xffff0000, v99
    v_mul_f32 v108, 0xbfb8aa3b, v100
    v_mul_f32 v109, 0xbfb8aa3b, v101
    v_mul_f32 v110, 0xbfb8aa3b, v102
    v_mul_f32 v111, 0xbfb8aa3b, v103
    v_mul_f32 v112, 0xbfb8aa3b, v104
    v_mul_f32 v113, 0xbfb8aa3b, v105
    v_mul_f32 v114, 0xbfb8aa3b, v106
    v_mul_f32 v115, 0xbfb8aa3b, v107
    v_exp_f32 v108, v108
    v_exp_f32 v109, v109
    v_exp_f32 v110, v110
    v_exp_f32 v111, v111
    v_exp_f32 v112, v112
    v_exp_f32 v113, v113
    v_exp_f32 v114, v114
    v_exp_f32 v115, v115
    v_add_f32 v108, 1.0, v108
    v_add_f32 v109, 1.0, v109
    v_add_f32 v110, 1.0, v110
    v_add_f32 v111, 1.0, v111
    v_add_f32 v112, 1.0, v112
    v_add_f32 v113, 1.0, v113
    v_add_f32 v114, 1.0, v114
    v_add_f32 v115, 1.0, v115
    v_rcp_f32 v108, v108
    v_rcp_f32 v109, v109
    v_rcp_f32 v110, v110
    v_rcp_f32 v111, v111
    v_rcp_f32 v112, v112
    v_rcp_f32 v113, v113
    v_rcp_f32 v114, v114
    v_rcp_f32 v115, v115
    v_mul_f32 v100, v100, v108
    v_mul_f32 v101, v101, v109
    v_mul_f32 v102, v102, v110
    v_mul_f32 v103, v103, v111
    v_mul_f32 v104, v104, v112
    v_mul_f32 v105, v105, v113
    v_mul_f32 v106, v106, v114
    v_mul_f32 v107, v107, v115
    v_cvt_pk_bf16_f32 v96, v100, v101
    v_cvt_pk_bf16_f32 v97, v102, v103
    v_cvt_pk_bf16_f32 v98, v104, v105
    v_cvt_pk_bf16_f32 v99, v106, v107
    v_add_u32 v20, 149504, v20
    ds_write_b128 v20, v[96:99]
    v_lshrrev_b32 v21, 4, v1
    v_lshlrev_b32 v21, 4, v21
    v_add_u32 v21, 149504, v21
    s_waitcnt lgkmcnt(0)
    ds_read_b128 v[32:35], v21 offset:0
    ds_read_b128 v[36:39], v21 offset:64
    ds_read_b128 v[40:43], v21 offset:128
    ds_read_b128 v[44:47], v21 offset:192
    ds_read_b128 v[48:51], v21 offset:256
    ds_read_b128 v[52:55], v21 offset:320
    ds_read_b128 v[56:59], v21 offset:384
    ds_read_b128 v[60:63], v21 offset:448
    ds_read_b128 v[64:67], v21 offset:512
    ds_read_b128 v[68:71], v21 offset:576
    ds_read_b128 v[72:75], v21 offset:640
    ds_read_b128 v[76:79], v21 offset:704
    ds_read_b128 v[80:83], v21 offset:768
    ds_read_b128 v[84:87], v21 offset:832
    ds_read_b128 v[88:91], v21 offset:896
    ds_read_b128 v[92:95], v21 offset:960
    s_barrier
    s_barrier
    s_barrier
    s_setprio 3
    s_add_u32 s11, s17, 0
    buffer_load_dwordx4 v[96:99], v9, s[96:99], s11 offen
    s_add_u32 s11, s17, 196608
    buffer_load_dwordx4 v[100:103], v9, s[96:99], s11 offen
    s_add_u32 s11, s17, 393216
    buffer_load_dwordx4 v[104:107], v9, s[96:99], s11 offen
    s_add_u32 s11, s17, 589824
    buffer_load_dwordx4 v[108:111], v9, s[96:99], s11 offen
    s_add_u32 s11, s17, 786432
    buffer_load_dwordx4 v[112:115], v9, s[96:99], s11 offen
    s_add_u32 s11, s17, 983040
    buffer_load_dwordx4 v[116:119], v9, s[96:99], s11 offen
    s_add_u32 s11, s17, 1179648
    buffer_load_dwordx4 v[120:123], v9, s[96:99], s11 offen
    s_add_u32 s11, s17, 1376256
    buffer_load_dwordx4 v[124:127], v9, s[96:99], s11 offen
    s_add_u32 s11, s17, 1572864
    buffer_load_dwordx4 v[128:131], v9, s[96:99], s11 offen
    s_add_u32 s11, s17, 1769472
    buffer_load_dwordx4 v[132:135], v9, s[96:99], s11 offen
    s_add_u32 s11, s17, 1966080
    buffer_load_dwordx4 v[136:139], v9, s[96:99], s11 offen
    s_add_u32 s11, s17, 2162688
    buffer_load_dwordx4 v[140:143], v9, s[96:99], s11 offen
    s_add_u32 s11, s17, 2359296
    buffer_load_dwordx4 v[144:147], v9, s[96:99], s11 offen
    s_add_u32 s11, s17, 2555904
    buffer_load_dwordx4 v[148:151], v9, s[96:99], s11 offen
    s_add_u32 s11, s17, 2752512
    buffer_load_dwordx4 v[152:155], v9, s[96:99], s11 offen
    s_add_u32 s11, s17, 2949120
    buffer_load_dwordx4 v[156:159], v9, s[96:99], s11 offen
    s_setprio 2
    s_waitcnt vmcnt(0) lgkmcnt(0)
    ds_write_b128 v20, v[96:99] offset:0
    ds_write_b128 v20, v[100:103] offset:1024
    ds_write_b128 v20, v[104:107] offset:2048
    ds_write_b128 v20, v[108:111] offset:3072
    ds_read_b64_tr_b16 v[96:97], v13 offset:0
    ds_read_b64_tr_b16 v[98:99], v13 offset:128
    ds_read_b64_tr_b16 v[100:101], v13 offset:1024
    ds_read_b64_tr_b16 v[102:103], v13 offset:1152
    ds_read_b64_tr_b16 v[104:105], v13 offset:2048
    ds_read_b64_tr_b16 v[106:107], v13 offset:2176
    ds_read_b64_tr_b16 v[108:109], v13 offset:3072
    ds_read_b64_tr_b16 v[110:111], v13 offset:3200
    s_waitcnt lgkmcnt(4)
    s_waitcnt lgkmcnt(0)
    ds_write_b128 v20, v[112:115] offset:0
    ds_write_b128 v20, v[116:119] offset:1024
    ds_write_b128 v20, v[120:123] offset:2048
    ds_write_b128 v20, v[124:127] offset:3072
    ds_read_b64_tr_b16 v[112:113], v13 offset:0
    ds_read_b64_tr_b16 v[114:115], v13 offset:128
    ds_read_b64_tr_b16 v[116:117], v13 offset:1024
    ds_read_b64_tr_b16 v[118:119], v13 offset:1152
    ds_read_b64_tr_b16 v[120:121], v13 offset:2048
    ds_read_b64_tr_b16 v[122:123], v13 offset:2176
    ds_read_b64_tr_b16 v[124:125], v13 offset:3072
    ds_read_b64_tr_b16 v[126:127], v13 offset:3200
    s_waitcnt lgkmcnt(4)
    s_waitcnt lgkmcnt(0)
    ds_write_b128 v20, v[128:131] offset:0
    ds_write_b128 v20, v[132:135] offset:1024
    ds_write_b128 v20, v[136:139] offset:2048
    ds_write_b128 v20, v[140:143] offset:3072
    ds_read_b64_tr_b16 v[128:129], v13 offset:0
    ds_read_b64_tr_b16 v[130:131], v13 offset:128
    ds_read_b64_tr_b16 v[132:133], v13 offset:1024
    ds_read_b64_tr_b16 v[134:135], v13 offset:1152
    ds_read_b64_tr_b16 v[136:137], v13 offset:2048
    ds_read_b64_tr_b16 v[138:139], v13 offset:2176
    ds_read_b64_tr_b16 v[140:141], v13 offset:3072
    ds_read_b64_tr_b16 v[142:143], v13 offset:3200
    s_waitcnt lgkmcnt(4)
    s_waitcnt lgkmcnt(0)
    ds_write_b128 v20, v[144:147] offset:0
    ds_write_b128 v20, v[148:151] offset:1024
    ds_write_b128 v20, v[152:155] offset:2048
    ds_write_b128 v20, v[156:159] offset:3072
    ds_read_b64_tr_b16 v[144:145], v13 offset:0
    ds_read_b64_tr_b16 v[146:147], v13 offset:128
    ds_read_b64_tr_b16 v[148:149], v13 offset:1024
    ds_read_b64_tr_b16 v[150:151], v13 offset:1152
    ds_read_b64_tr_b16 v[152:153], v13 offset:2048
    ds_read_b64_tr_b16 v[154:155], v13 offset:2176
    ds_read_b64_tr_b16 v[156:157], v13 offset:3072
    ds_read_b64_tr_b16 v[158:159], v13 offset:3200
    s_waitcnt lgkmcnt(4)
    s_waitcnt lgkmcnt(0)
    s_setprio 2
    v_mfma_f32_16x16x32_bf16 v[16:19], v[32:35], v[96:99], v[16:19]
    v_mfma_f32_16x16x32_bf16 v[16:19], v[36:39], v[100:103], v[16:19]
    v_mfma_f32_16x16x32_bf16 v[16:19], v[40:43], v[104:107], v[16:19]
    v_mfma_f32_16x16x32_bf16 v[16:19], v[44:47], v[108:111], v[16:19]
    v_mfma_f32_16x16x32_bf16 v[16:19], v[48:51], v[112:115], v[16:19]
    v_mfma_f32_16x16x32_bf16 v[16:19], v[52:55], v[116:119], v[16:19]
    v_mfma_f32_16x16x32_bf16 v[16:19], v[56:59], v[120:123], v[16:19]
    v_mfma_f32_16x16x32_bf16 v[16:19], v[60:63], v[124:127], v[16:19]
    v_mfma_f32_16x16x32_bf16 v[16:19], v[64:67], v[128:131], v[16:19]
    v_mfma_f32_16x16x32_bf16 v[16:19], v[68:71], v[132:135], v[16:19]
    v_mfma_f32_16x16x32_bf16 v[16:19], v[72:75], v[136:139], v[16:19]
    v_mfma_f32_16x16x32_bf16 v[16:19], v[76:79], v[140:143], v[16:19]
    v_mfma_f32_16x16x32_bf16 v[16:19], v[80:83], v[144:147], v[16:19]
    v_mfma_f32_16x16x32_bf16 v[16:19], v[84:87], v[148:151], v[16:19]
    v_mfma_f32_16x16x32_bf16 v[16:19], v[88:91], v[152:155], v[16:19]
    v_mfma_f32_16x16x32_bf16 v[16:19], v[92:95], v[156:159], v[16:19]
    s_nop 7
    v_cvt_pk_bf16_f32 v16, v16, v16
    v_lshlrev_b32 v16, 16, v16
    s_lshr_b32 s8, s16, 5
    s_lshl_b32 s9, s8, 2
    s_lshr_b32 s10, 0x010010, s9
    s_and_b32 s10, s10, 1
    s_cmp_eq_u32 s10, 0
    s_cbranch_scc1 MODA_8
    v_add_f32 v16, 1.0, v16
    v_cvt_pk_bf16_f32 v16, v16, v16
    v_lshlrev_b32 v16, 16, v16
MODA_8:
    v_lshlrev_b32 v10, 2, v1
    v_lshrrev_b32 v11, 1, v1
    v_xor_b32 v11, v11, v1
    v_and_b32 v11, 4, v11
    v_mul_u32_u24 v11, 3, v11
    v_xor_b32 v11, v11, v1
    v_lshlrev_b32 v11, 1, v11
    s_lshl_b32 s10, s16, 6
    s_mov_b64 exec, 0xffff
    buffer_store_dword v16, v10, s[52:55], s10 offen offset:0 sc1
    s_lshr_b32 s8, 0x701723, s9
    s_and_b32 s8, s8, 7
    s_cmp_eq_u32 s8, 7
    s_cbranch_scc1 MODB_9
    s_lshl_b32 s8, s8, 10
    s_and_b32 s9, s16, 31
    s_lshl_b32 s9, s9, 5
    s_add_u32 s8, s8, s9
    s_add_u32 s8, s8, 61440
    buffer_store_short_d16_hi v16, v11, s[52:55], s8 offen sc1
MODB_9:
    s_mov_b64 exec, -1
    s_waitcnt vmcnt(0)
    s_lshl_b32 s10, s16, 2
    s_add_u32 s10, s10, 6912
    s_lshl_b32 s10, s10, 6
    s_add_u32 s10, s10, 524288
    v_mov_b32 v6, s100
    v_mov_b32 v7, s101
    v_lshlrev_b32 v8, 19, v1
    s_mov_b64 exec, 1
    buffer_store_dwordx2 v[6:7], v8, s[52:55], s10 offen sc1
    s_mov_b64 exec, -1
    s_branch P3_XW
P3_XB3:
    s_barrier
    s_barrier
    s_barrier
    s_cmp_eq_u32 s60, 10
    s_cbranch_scc1 P3_LENE
P3_XW:
    s_setprio 2
    v_and_b32 v11, 15, v1
    v_lshrrev_b32 v12, 4, v1
    v_lshl_add_u32 v11, v12, 5, v11
    v_lshlrev_b32 v11, 8, v11
    s_sleep 16
    s_sleep 16
    s_bfe_u32 s4, s2, 0x30003
    s_lshl_b32 s4, s4, 14
    s_add_u32 s4, s4, 659456
    s_mov_b32 s6, 0x0fffffff
    s_mov_b32 s95, 0x20000
    s_waitcnt vmcnt(0)
    s_mov_b32 exec_lo, s6
    s_mov_b32 exec_hi, 0
    buffer_load_dwordx2 v[160:161], v11, s[52:55], s4 offen sc1
    s_sleep 12
POLL_10:
    buffer_load_dwordx2 v[162:163], v11, s[52:55], s4 offen sc1
    s_waitcnt vmcnt(1)
    v_cmp_ne_u64 vcc, s[100:101], v[160:161]
    s_nop 0
    s_and_b64 exec, exec, vcc
    s_cbranch_scc0 POLLE_11
    s_sleep 12
    buffer_load_dwordx2 v[160:161], v11, s[52:55], s4 offen sc1
    s_waitcnt vmcnt(1)
    v_cmp_ne_u64 vcc, s[100:101], v[162:163]
    s_nop 0
    s_and_b64 exec, exec, vcc
    s_cbranch_scc0 POLLE_11
    s_sleep 12
    s_sub_u32 s95, s95, 1
    s_cmp_lg_u32 s95, 0
    s_cbranch_scc1 POLL_10
POLLE_11:
    s_mov_b64 exec, -1
    v_mov_b32 v11, 161792
    v_mov_b32 v12, 1
    ds_write_b32 v11, v12 offset:24
    s_branch P3_LENE
P3_LOADER:
    s_cmp_ge_u32 s60, 10
    s_cbranch_scc1 P3_X
    s_cmp_eq_u32 s60, 8
    s_cbranch_scc0 P3_PRE9
    v_mov_b32 v20, 0
    v_mov_b32 v21, 0
    v_mov_b32 v24, 0
    v_mov_b32 v25, 0
    v_mov_b32 v26, 0
    v_mov_b32 v27, 0
    v_mov_b32 v28, 0
    v_mov_b32 v29, 0
    v_mov_b32 v24, 0x7ff00000
    v_and_b32 v25, 15, v1
    v_lshrrev_b32 v26, 4, v1
    v_lshlrev_b32 v27, 10, v25
    v_lshl_add_u32 v27, v26, 4, v27
    v_add_u32 v27, 61440, v27
    v_cmp_gt_u32 vcc, 2, v25
    s_nop 1
    v_cndmask_b32 v21, v24, v27, vcc
    v_lshrrev_b32 v9, 1, v1
    v_mul_u32_u24 v9, 3584, v9
    v_and_b32 v10, 1, v1
    v_lshl_add_u32 v9, v10, 4, v9
    v_lshrrev_b32 v11, 4, v1
    v_bfe_u32 v13, v1, 2, 3
    v_lshrrev_b32 v11, 5, v1
    v_lshl_add_u32 v13, v11, 4, v13
    v_lshlrev_b32 v13, 5, v13
    v_and_b32 v14, 3, v1
    v_lshl_add_u32 v13, v14, 3, v13
    v_add_u32 v13, 153600, v13
    v_mov_b32 v16, 0
    v_mov_b32 v17, 0
    v_mov_b32 v18, 0
    v_mov_b32 v19, 0
    v_and_b32 v22, 7, v1
    v_min_u32 v22, 6, v22
    v_bfe_u32 v23, v1, 3, 1
    v_mul_u32_u24 v23, 112, v23
    v_add_u32 v22, v22, v23
    v_lshlrev_b32 v22, 8, v22
    v_lshlrev_b32 v23, 8, v1
    s_branch P3_PRED
P3_PRE9:
    v_add_u32 v9, 0, v1
    v_mul_u32_u24 v10, 4682, v9
    v_lshrrev_b32 v10, 16, v10
    v_mul_u32_u24 v11, 14, v10
    v_sub_u32 v11, v9, v11
    v_mul_u32_u24 v10, 3584, v10
    v_lshl_add_u32 v24, v11, 7, v10
    v_add_u32 v9, 64, v1
    v_mul_u32_u24 v10, 4682, v9
    v_lshrrev_b32 v10, 16, v10
    v_mul_u32_u24 v11, 14, v10
    v_sub_u32 v11, v9, v11
    v_mul_u32_u24 v10, 3584, v10
    v_lshl_add_u32 v25, v11, 7, v10
    v_add_u32 v9, 128, v1
    v_mul_u32_u24 v10, 4682, v9
    v_lshrrev_b32 v10, 16, v10
    v_mul_u32_u24 v11, 14, v10
    v_sub_u32 v11, v9, v11
    v_mul_u32_u24 v10, 3584, v10
    v_lshl_add_u32 v26, v11, 7, v10
    v_add_u32 v9, 192, v1
    v_mul_u32_u24 v10, 4682, v9
    v_lshrrev_b32 v10, 16, v10
    v_mul_u32_u24 v11, 14, v10
    v_sub_u32 v11, v9, v11
    v_mul_u32_u24 v10, 3584, v10
    v_lshl_add_u32 v27, v11, 7, v10
    v_cmp_gt_u32 vcc, 224, v9
    v_mov_b32 v13, 0x7ff00000
    s_nop 0
    v_cndmask_b32 v27, v13, v27, vcc
    v_lshrrev_b32 v28, 2, v1
    v_mul_u32_u24 v28, 6144, v28
    v_and_b32 v10, 3, v1
    v_lshl_add_u32 v28, v10, 7, v28
    v_lshlrev_b32 v29, 7, v1
    v_lshrrev_b32 v3, 3, v1
    v_bfe_u32 v8, v1, 2, 1
    v_bfe_u32 v9, v1, 4, 1
    v_xor_b32 v8, v8, v9
    v_lshlrev_b32 v20, 10, v3
    v_lshl_add_u32 v20, v8, 6, v20
    v_and_b32 v8, 3, v1
    v_lshl_add_u32 v20, v8, 4, v20
    v_add_u32 v21, 7168, v20
    v_add_u32 v22, 14336, v20
    v_add_u32 v23, 21504, v20
P3_PRED:
    s_sub_u32 s23, s60, 8
    s_lshr_b32 s20, s25, 2
    s_lshl_b32 s20, s20, 7
    s_add_u32 s19, s20, 0
    s_lshl_b32 s18, s26, 2
    s_lshl_b32 s18, 15, s18
    s_or_b32 s18, s18, 0x3000000f
    s_mul_i32 s20, s23, 2097152
    s_add_u32 s20, s20, s27
    s_add_u32 s20, s20, 3145728
    s_lshl_b32 s21, s23, 16
    s_lshl_b32 s22, s26, 13
    s_add_u32 s22, s22, s27
    s_lshl_b32 s24, s23, 12
    s_add_u32 s22, s22, s24
    s_add_u32 s22, s22, 1048576
    s_add_u32 s24, s24, 131072
    s_mov_b32 s6, 6
    s_mov_b32 s7, 0
    s_lshl_b32 s19, s19, 6
    s_add_u32 s19, s19, 524288
    v_min_u32 v8, 31, v1
    v_lshlrev_b32 v8, 8, v8
    s_mov_b32 s95, 0x20000
    s_waitcnt vmcnt(0)
    s_mov_b32 exec_lo, s18
    s_mov_b32 exec_hi, 0
    buffer_load_dwordx2 v[160:161], v8, s[52:55], s19 offen sc1
POLL_12:
    buffer_load_dwordx2 v[162:163], v8, s[52:55], s19 offen sc1
    s_waitcnt vmcnt(1)
    v_cmp_ne_u64 vcc, s[100:101], v[160:161]
    s_nop 0
    s_and_b64 exec, exec, vcc
    s_cbranch_scc0 POLLE_13
    buffer_load_dwordx2 v[160:161], v8, s[52:55], s19 offen sc1
    s_waitcnt vmcnt(1)
    v_cmp_ne_u64 vcc, s[100:101], v[162:163]
    s_nop 0
    s_and_b64 exec, exec, vcc
    s_cbranch_scc0 POLLE_13
    s_sub_u32 s95, s95, 1
    s_cmp_lg_u32 s95, 0
    s_cbranch_scc1 POLL_12
POLLE_13:
    s_mov_b64 exec, -1
    s_mov_b32 m0, s24
    s_nop 0
    buffer_load_dwordx4 v4, s[52:55], s22 offen offset:0 sc1 lds
    buffer_load_dwordx4 v4, s[52:55], s22 offen offset:1024 sc1 lds
    buffer_load_dwordx4 v4, s[52:55], s22 offen offset:2048 sc1 lds
    buffer_load_dwordx4 v4, s[52:55], s22 offen offset:3072 sc1 lds
    s_add_u32 m0, s21, 0
    s_add_u32 s8, s20, 0
    buffer_load_dwordx4 v4, s[52:55], s8 offen offset:0 sc1 lds
    buffer_load_dwordx4 v4, s[52:55], s8 offen offset:1024 sc1 lds
    s_add_u32 m0, s21, 57344
    s_add_u32 s8, s20, 57344
    buffer_load_dwordx4 v4, s[52:55], s8 offen offset:0 sc1 lds
    buffer_load_dwordx4 v4, s[52:55], s8 offen offset:1024 sc1 lds
    s_add_u32 m0, s21, 2048
    s_add_u32 s8, s20, 2048
    buffer_load_dwordx4 v4, s[52:55], s8 offen offset:0 sc1 lds
    buffer_load_dwordx4 v4, s[52:55], s8 offen offset:1024 sc1 lds
    buffer_load_dwordx4 v4, s[52:55], s8 offen offset:2048 sc1 lds
    buffer_load_dwordx4 v4, s[52:55], s8 offen offset:3072 sc1 lds
    s_add_u32 m0, s21, 6144
    s_add_u32 s8, s20, 6144
    buffer_load_dwordx4 v4, s[52:55], s8 offen offset:0 sc1 lds
    buffer_load_dwordx4 v4, s[52:55], s8 offen offset:1024 sc1 lds
    s_add_u32 m0, s21, 59392
    s_add_u32 s8, s20, 59392
    buffer_load_dwordx4 v4, s[52:55], s8 offen offset:0 sc1 lds
    buffer_load_dwordx4 v4, s[52:55], s8 offen offset:1024 sc1 lds
    s_waitcnt vmcnt(8)
    s_barrier
    buffer_load_dwordx2 v[164:165], v8, s[52:55], s19 offen sc1
    s_waitcnt vmcnt(1)
    s_barrier
    s_waitcnt vmcnt(0)
    v_cmp_ne_u64 vcc, s[100:101], v[164:165]
    s_cbranch_vccz POLLF_14
    s_mov_b64 exec, vcc
    s_mov_b32 s95, 0x20000
    s_waitcnt vmcnt(0)
    buffer_load_dwordx2 v[160:161], v8, s[52:55], s19 offen sc1
POLL_15:
    buffer_load_dwordx2 v[162:163], v8, s[52:55], s19 offen sc1
    s_waitcnt vmcnt(1)
    v_cmp_ne_u64 vcc, s[100:101], v[160:161]
    s_nop 0
    s_and_b64 exec, exec, vcc
    s_cbranch_scc0 POLLE_16
    buffer_load_dwordx2 v[160:161], v8, s[52:55], s19 offen sc1
    s_waitcnt vmcnt(1)
    v_cmp_ne_u64 vcc, s[100:101], v[162:163]
    s_nop 0
    s_and_b64 exec, exec, vcc
    s_cbranch_scc0 POLLE_16
    s_sub_u32 s95, s95, 1
    s_cmp_lg_u32 s95, 0
    s_cbranch_scc1 POLL_15
POLLE_16:
    s_mov_b64 exec, -1
POLLF_14:
P3_ALLF:
    s_add_u32 m0, s21, 8192
    s_add_u32 s8, s20, 8192
    buffer_load_dwordx4 v4, s[52:55], s8 offen offset:0 sc1 lds
    buffer_load_dwordx4 v4, s[52:55], s8 offen offset:1024 sc1 lds
    buffer_load_dwordx4 v4, s[52:55], s8 offen offset:2048 sc1 lds
    buffer_load_dwordx4 v4, s[52:55], s8 offen offset:3072 sc1 lds
    s_add_u32 m0, s21, 12288
    s_add_u32 s8, s20, 12288
    buffer_load_dwordx4 v4, s[52:55], s8 offen offset:0 sc1 lds
    buffer_load_dwordx4 v4, s[52:55], s8 offen offset:1024 sc1 lds
    buffer_load_dwordx4 v4, s[52:55], s8 offen offset:2048 sc1 lds
    buffer_load_dwordx4 v4, s[52:55], s8 offen offset:3072 sc1 lds
    s_add_u32 m0, s21, 16384
    s_add_u32 s8, s20, 16384
    buffer_load_dwordx4 v4, s[52:55], s8 offen offset:0 sc1 lds
    buffer_load_dwordx4 v4, s[52:55], s8 offen offset:1024 sc1 lds
    buffer_load_dwordx4 v4, s[52:55], s8 offen offset:2048 sc1 lds
    buffer_load_dwordx4 v4, s[52:55], s8 offen offset:3072 sc1 lds
    s_add_u32 m0, s21, 20480
    s_add_u32 s8, s20, 20480
    buffer_load_dwordx4 v4, s[52:55], s8 offen offset:0 sc1 lds
    buffer_load_dwordx4 v4, s[52:55], s8 offen offset:1024 sc1 lds
    buffer_load_dwordx4 v4, s[52:55], s8 offen offset:2048 sc1 lds
    buffer_load_dwordx4 v4, s[52:55], s8 offen offset:3072 sc1 lds
    s_add_u32 m0, s21, 24576
    s_add_u32 s8, s20, 24576
    buffer_load_dwordx4 v4, s[52:55], s8 offen offset:0 sc1 lds
    buffer_load_dwordx4 v4, s[52:55], s8 offen offset:1024 sc1 lds
    buffer_load_dwordx4 v4, s[52:55], s8 offen offset:2048 sc1 lds
    buffer_load_dwordx4 v4, s[52:55], s8 offen offset:3072 sc1 lds
    s_add_u32 m0, s21, 28672
    s_add_u32 s8, s20, 28672
    buffer_load_dwordx4 v4, s[52:55], s8 offen offset:0 sc1 lds
    buffer_load_dwordx4 v4, s[52:55], s8 offen offset:1024 sc1 lds
    buffer_load_dwordx4 v4, s[52:55], s8 offen offset:2048 sc1 lds
    buffer_load_dwordx4 v4, s[52:55], s8 offen offset:3072 sc1 lds
    s_add_u32 m0, s21, 32768
    s_add_u32 s8, s20, 32768
    buffer_load_dwordx4 v4, s[52:55], s8 offen offset:0 sc1 lds
    buffer_load_dwordx4 v4, s[52:55], s8 offen offset:1024 sc1 lds
    buffer_load_dwordx4 v4, s[52:55], s8 offen offset:2048 sc1 lds
    buffer_load_dwordx4 v4, s[52:55], s8 offen offset:3072 sc1 lds
    s_add_u32 m0, s21, 36864
    s_add_u32 s8, s20, 36864
    buffer_load_dwordx4 v4, s[52:55], s8 offen offset:0 sc1 lds
    buffer_load_dwordx4 v4, s[52:55], s8 offen offset:1024 sc1 lds
    buffer_load_dwordx4 v4, s[52:55], s8 offen offset:2048 sc1 lds
    buffer_load_dwordx4 v4, s[52:55], s8 offen offset:3072 sc1 lds
    s_add_u32 m0, s21, 40960
    s_add_u32 s8, s20, 40960
    buffer_load_dwordx4 v4, s[52:55], s8 offen offset:0 sc1 lds
    buffer_load_dwordx4 v4, s[52:55], s8 offen offset:1024 sc1 lds
    buffer_load_dwordx4 v4, s[52:55], s8 offen offset:2048 sc1 lds
    buffer_load_dwordx4 v4, s[52:55], s8 offen offset:3072 sc1 lds
    s_add_u32 m0, s21, 45056
    s_add_u32 s8, s20, 45056
    buffer_load_dwordx4 v4, s[52:55], s8 offen offset:0 sc1 lds
    buffer_load_dwordx4 v4, s[52:55], s8 offen offset:1024 sc1 lds
    buffer_load_dwordx4 v4, s[52:55], s8 offen offset:2048 sc1 lds
    buffer_load_dwordx4 v4, s[52:55], s8 offen offset:3072 sc1 lds
    s_add_u32 m0, s21, 49152
    s_add_u32 s8, s20, 49152
    buffer_load_dwordx4 v4, s[52:55], s8 offen offset:0 sc1 lds
    buffer_load_dwordx4 v4, s[52:55], s8 offen offset:1024 sc1 lds
    buffer_load_dwordx4 v4, s[52:55], s8 offen offset:2048 sc1 lds
    buffer_load_dwordx4 v4, s[52:55], s8 offen offset:3072 sc1 lds
    s_add_u32 m0, s21, 53248
    s_add_u32 s8, s20, 53248
    buffer_load_dwordx4 v4, s[52:55], s8 offen offset:0 sc1 lds
    buffer_load_dwordx4 v4, s[52:55], s8 offen offset:1024 sc1 lds
    buffer_load_dwordx4 v4, s[52:55], s8 offen offset:2048 sc1 lds
    buffer_load_dwordx4 v4, s[52:55], s8 offen offset:3072 sc1 lds
    s_add_u32 m0, s21, 61440
    s_add_u32 s8, s20, 61440
    buffer_load_dwordx4 v4, s[52:55], s8 offen offset:0 sc1 lds
    buffer_load_dwordx4 v4, s[52:55], s8 offen offset:1024 sc1 lds
    buffer_load_dwordx4 v4, s[52:55], s8 offen offset:2048 sc1 lds
    buffer_load_dwordx4 v4, s[52:55], s8 offen offset:3072 sc1 lds
P3_LKV2:
    s_waitcnt vmcnt(0)
    s_barrier
    s_cmp_eq_u32 s60, 8
    s_cbranch_scc0 P3_HPREF
P3_NOMOD:
    s_setprio 2
    s_cmp_ge_u32 s2, 224
    s_cbranch_scc1 P3_NS8
    s_lshr_b32 s4, s2, 3
    s_bfe_u32 s8, s2, 0x20001
    s_mul_i32 s8, s8, 28
    s_add_u32 s8, s8, s4
    s_and_b32 s12, s2, 1
    s_mul_i32 s12, s12, 56
    s_cmp_ge_u32 s8, 56
    s_cselect_b32 s4, s44, s40
    s_cselect_b32 s5, s45, s41
    s_cselect_b32 s6, s46, s42
    s_cselect_b32 s13, 56, 0
    s_cselect_b32 s9, 14336, 0
    s_cselect_b32 s14, 112, 0
    s_mov_b32 s7, 0x00020000
    s_sub_u32 s8, s8, s13
    s_add_u32 s8, s8, s12
    s_add_u32 s14, s14, s8
    s_lshl_b32 s10, s8, 5
    s_waitcnt vmcnt(0)
    s_mov_b32 m0, 153600
    s_add_u32 s11, s10, 917504
    buffer_load_dwordx4 v9, s[4:7], s11 offen lds
    s_mov_b32 m0, 154624
    s_add_u32 s11, s10, 1032192
    buffer_load_dwordx4 v9, s[4:7], s11 offen lds
    s_mov_b32 m0, 155648
    s_add_u32 s11, s10, 1146880
    buffer_load_dwordx4 v9, s[4:7], s11 offen lds
    s_mov_b32 m0, 156672
    s_add_u32 s11, s10, 1261568
    buffer_load_dwordx4 v9, s[4:7], s11 offen lds
    s_waitcnt vmcnt(2)
    ds_read_b64_tr_b16 v[128:129], v13 offset:0
    ds_read_b64_tr_b16 v[130:131], v13 offset:256
    ds_read_b64_tr_b16 v[132:133], v13 offset:1024
    ds_read_b64_tr_b16 v[134:135], v13 offset:1280
    s_waitcnt lgkmcnt(0)
    s_mov_b32 m0, 153600
    s_add_u32 s11, s10, 1376256
    buffer_load_dwordx4 v9, s[4:7], s11 offen lds
    s_mov_b32 m0, 154624
    s_add_u32 s11, s10, 1490944
    buffer_load_dwordx4 v9, s[4:7], s11 offen lds
    s_waitcnt vmcnt(2)
    ds_read_b64_tr_b16 v[136:137], v13 offset:2048
    ds_read_b64_tr_b16 v[138:139], v13 offset:2304
    ds_read_b64_tr_b16 v[140:141], v13 offset:3072
    ds_read_b64_tr_b16 v[142:143], v13 offset:3328
    s_waitcnt lgkmcnt(0)
    s_mov_b32 m0, 155648
    s_add_u32 s11, s10, 1605632
    buffer_load_dwordx4 v9, s[4:7], s11 offen lds
    s_mov_b32 m0, 156672
    s_add_u32 s11, s10, 1720320
    buffer_load_dwordx4 v9, s[4:7], s11 offen lds
    s_waitcnt vmcnt(2)
    ds_read_b64_tr_b16 v[144:145], v13 offset:0
    ds_read_b64_tr_b16 v[146:147], v13 offset:256
    ds_read_b64_tr_b16 v[148:149], v13 offset:1024
    ds_read_b64_tr_b16 v[150:151], v13 offset:1280
    s_waitcnt lgkmcnt(0)
    s_waitcnt vmcnt(0)
    ds_read_b64_tr_b16 v[152:153], v13 offset:2048
    ds_read_b64_tr_b16 v[154:155], v13 offset:2304
    ds_read_b64_tr_b16 v[156:157], v13 offset:3072
    ds_read_b64_tr_b16 v[158:159], v13 offset:3328
    s_waitcnt lgkmcnt(0)
    s_mul_i32 s10, s8, 147
    s_lshr_b32 s10, s10, 10
    s_mul_i32 s11, s10, 7
    s_sub_u32 s11, s8, s11
    s_mul_i32 s10, s10, 224*1024
    s_lshl_b32 s11, s11, 11
    s_add_u32 s10, s10, s11
    s_add_u32 s10, s10, s9
    s_add_u32 s10, s10, 23183360
    buffer_store_dwordx4 v[128:131], v4, s[52:55], s10 offen offset:0 sc1
    s_sleep 2
    buffer_store_dwordx4 v[132:135], v4, s[52:55], s10 offen offset:1024 sc1
    s_add_u32 s10, s10, 28*1024
    s_sleep 2
    buffer_store_dwordx4 v[136:139], v4, s[52:55], s10 offen offset:0 sc1
    s_sleep 2
    buffer_store_dwordx4 v[140:143], v4, s[52:55], s10 offen offset:1024 sc1
    s_add_u32 s10, s10, 28*1024
    s_sleep 2
    buffer_store_dwordx4 v[144:147], v4, s[52:55], s10 offen offset:0 sc1
    s_sleep 2
    buffer_store_dwordx4 v[148:151], v4, s[52:55], s10 offen offset:1024 sc1
    s_add_u32 s10, s10, 28*1024
    s_sleep 2
    buffer_store_dwordx4 v[152:155], v4, s[52:55], s10 offen offset:0 sc1
    s_sleep 2
    buffer_store_dwordx4 v[156:159], v4, s[52:55], s10 offen offset:1024 sc1
    s_add_u32 s10, s10, 28*1024
    s_sleep 2
P3_NS8:
    s_mov_b32 s4, 983040
    s_mov_b32 s95, 0x20000
    s_waitcnt vmcnt(0)
    buffer_load_dwordx2 v[160:161], v23, s[52:55], s4 offen sc1
    s_sleep 12
POLL_17:
    buffer_load_dwordx2 v[162:163], v23, s[52:55], s4 offen sc1
    s_waitcnt vmcnt(1)
    v_cmp_ne_u64 vcc, s[100:101], v[160:161]
    s_nop 0
    s_and_b64 exec, exec, vcc
    s_cbranch_scc0 POLLE_18
    s_sleep 12
    buffer_load_dwordx2 v[160:161], v23, s[52:55], s4 offen sc1
    s_waitcnt vmcnt(1)
    v_cmp_ne_u64 vcc, s[100:101], v[162:163]
    s_nop 0
    s_and_b64 exec, exec, vcc
    s_cbranch_scc0 POLLE_18
    s_sleep 12
    s_sub_u32 s95, s95, 1
    s_cmp_lg_u32 s95, 0
    s_cbranch_scc1 POLL_17
POLLE_18:
    s_mov_b64 exec, -1
    s_mov_b32 s4, 999424
    s_mov_b32 s95, 0x20000
    s_waitcnt vmcnt(0)
    buffer_load_dwordx2 v[160:161], v23, s[52:55], s4 offen sc1
    s_sleep 12
POLL_19:
    buffer_load_dwordx2 v[162:163], v23, s[52:55], s4 offen sc1
    s_waitcnt vmcnt(1)
    v_cmp_ne_u64 vcc, s[100:101], v[160:161]
    s_nop 0
    s_and_b64 exec, exec, vcc
    s_cbranch_scc0 POLLE_20
    s_sleep 12
    buffer_load_dwordx2 v[160:161], v23, s[52:55], s4 offen sc1
    s_waitcnt vmcnt(1)
    v_cmp_ne_u64 vcc, s[100:101], v[162:163]
    s_nop 0
    s_and_b64 exec, exec, vcc
    s_cbranch_scc0 POLLE_20
    s_sleep 12
    s_sub_u32 s95, s95, 1
    s_cmp_lg_u32 s95, 0
    s_cbranch_scc1 POLL_19
POLLE_20:
    s_mov_b64 exec, -1
    v_mov_b32 v11, 161792
    v_mov_b32 v12, 1
    v_mov_b32 v14, s100
    v_mov_b32 v15, s101
    ds_write_b64 v11, v[14:15] offset:48
    ds_write_b32 v11, v12 offset:20
    s_cmp_ge_u32 s2, 224
    s_cbranch_scc1 P3_NT8
    buffer_load_dwordx4 v[64:67], v21, s[52:55], 0 offen offset:512 sc1
    buffer_load_dwordx4 v[68:71], v21, s[52:55], 0 offen offset:576 sc1
    buffer_load_dwordx4 v[72:75], v21, s[52:55], 0 offen offset:640 sc1
    buffer_load_dwordx4 v[76:79], v21, s[52:55], 0 offen offset:704 sc1
    buffer_load_dwordx4 v[80:83], v21, s[52:55], 0 offen offset:768 sc1
    buffer_load_dwordx4 v[84:87], v21, s[52:55], 0 offen offset:832 sc1
    buffer_load_dwordx4 v[88:91], v21, s[52:55], 0 offen offset:896 sc1
    buffer_load_dwordx4 v[92:95], v21, s[52:55], 0 offen offset:960 sc1
    s_waitcnt vmcnt(0)
    s_setprio 2
    v_mfma_f32_16x16x32_bf16 v[16:19], v[64:67], v[128:131], v[16:19]
    v_mfma_f32_16x16x32_bf16 v[16:19], v[68:71], v[132:135], v[16:19]
    v_mfma_f32_16x16x32_bf16 v[16:19], v[72:75], v[136:139], v[16:19]
    v_mfma_f32_16x16x32_bf16 v[16:19], v[76:79], v[140:143], v[16:19]
    v_mfma_f32_16x16x32_bf16 v[16:19], v[80:83], v[144:147], v[16:19]
    v_mfma_f32_16x16x32_bf16 v[16:19], v[84:87], v[148:151], v[16:19]
    v_mfma_f32_16x16x32_bf16 v[16:19], v[88:91], v[152:155], v[16:19]
    v_mfma_f32_16x16x32_bf16 v[16:19], v[92:95], v[156:159], v[16:19]
    v_lshlrev_b32 v10, 3, v1
    v_add_u32 v10, 153600, v10
    s_nop 5
    ds_write_b64 v10, v[16:17]
    ds_write_b32 v11, v12 offset:28
P3_NT8:
    s_bfe_u32 s4, s2, 0x30003
    s_and_b32 s5, s2, 1
    s_lshl3_add_u32 s5, s5, s4
    s_mul_i32 s4, s5, 1792
    s_add_u32 s4, s4, 917504
    s_mov_b32 s6, 0xffff
    s_mov_b32 s95, 0x20000
    s_waitcnt vmcnt(0)
    s_mov_b32 exec_lo, s6
    s_mov_b32 exec_hi, 0
    buffer_load_dwordx2 v[160:161], v22, s[52:55], s4 offen sc1
    s_sleep 12
POLL_21:
    buffer_load_dwordx2 v[162:163], v22, s[52:55], s4 offen sc1
    s_waitcnt vmcnt(1)
    v_cmp_ne_u64 vcc, s[100:101], v[160:161]
    s_nop 0
    s_and_b64 exec, exec, vcc
    s_cbranch_scc0 POLLE_22
    s_sleep 12
    buffer_load_dwordx2 v[160:161], v22, s[52:55], s4 offen sc1
    s_waitcnt vmcnt(1)
    v_cmp_ne_u64 vcc, s[100:101], v[162:163]
    s_nop 0
    s_and_b64 exec, exec, vcc
    s_cbranch_scc0 POLLE_22
    s_sleep 12
    s_sub_u32 s95, s95, 1
    s_cmp_lg_u32 s95, 0
    s_cbranch_scc1 POLL_21
POLLE_22:
    s_mov_b64 exec, -1
    s_lshr_b32 s4, s2, 6
    s_lshl2_add_u32 s4, s5, s4
    s_mul_i32 s4, s4, 56*1024
    s_add_u32 s4, s4, 23068672
    v_lshlrev_b32 v22, 7, v1
    buffer_load_dword v24, v22, s[52:55], s4 offen sc1
    s_add_u32 s4, s4, 8192
    buffer_load_dword v25, v22, s[52:55], s4 offen sc1
    s_add_u32 s4, s4, 8192
    buffer_load_dword v26, v22, s[52:55], s4 offen sc1
    s_add_u32 s4, s4, 8192
    buffer_load_dword v27, v22, s[52:55], s4 offen sc1
    s_add_u32 s4, s4, 8192
    buffer_load_dword v28, v22, s[52:55], s4 offen sc1
    s_add_u32 s4, s4, 8192
    buffer_load_dword v29, v22, s[52:55], s4 offen sc1
    s_add_u32 s4, s4, 8192
    buffer_load_dword v30, v22, s[52:55], s4 offen sc1
    s_add_u32 s4, s4, 8192
    s_branch P3_LEND
P3_HPREF:
    s_lshr_b32 s4, s2, 3
    s_mul_i32 s5, s4, 16*6144
    s_and_b32 s6, s2, 7
    s_lshl_b32 s6, s6, 9
    s_add_u32 s5, s5, s6
    s_add_u32 s5, s5, 2048
    buffer_load_dword v32, v28, s[96:99], s5 offen
    s_setprio 2
    s_waitcnt vmcnt(0)
    s_lshl_b32 s5, s4, 14
    buffer_load_dword v33, v29, s[36:39], s5 offen
    s_add_u32 s5, s5, 8192
    buffer_load_dword v34, v29, s[36:39], s5 offen
    s_and_b32 s6, s2, 1
    s_mul_i32 s6, s6, 1792
    s_mul_i32 s7, s4, 16*3584
    s_add_u32 s6, s6, s7
    s_mov_b32 s15, s6
    s_mov_b64 exec, -1
    s_branch P3_LEND
P3_EXT:
    s_lshr_b32 s4, s2, 3
    s_bfe_u32 s8, s2, 0x20001
    s_mul_i32 s8, s8, 28
    s_add_u32 s8, s8, s4
    s_and_b32 s12, s2, 1
    s_mul_i32 s12, s12, 56
    s_cmp_ge_u32 s8, 56
    s_cselect_b32 s4, s44, s40
    s_cselect_b32 s5, s45, s41
    s_cselect_b32 s6, s46, s42
    s_cselect_b32 s13, 56, 0
    s_cselect_b32 s9, 14336, 0
    s_cselect_b32 s14, 112, 0
    s_mov_b32 s7, 0x00020000
    s_sub_u32 s8, s8, s13
    s_add_u32 s8, s8, s12
    s_add_u32 s14, s14, s8
    s_lshl_b32 s10, s8, 5
    s_waitcnt vmcnt(0)
    s_mov_b32 m0, 157696
    s_add_u32 s11, s10, 0
    buffer_load_dwordx4 v9, s[4:7], s11 offen lds
    s_mov_b32 m0, 158720
    s_add_u32 s11, s10, 114688
    buffer_load_dwordx4 v9, s[4:7], s11 offen lds
    s_mov_b32 m0, 159744
    s_add_u32 s11, s10, 229376
    buffer_load_dwordx4 v9, s[4:7], s11 offen lds
    s_mov_b32 m0, 160768
    s_add_u32 s11, s10, 344064
    buffer_load_dwordx4 v9, s[4:7], s11 offen lds
    s_waitcnt vmcnt(2)
    ds_read_b64_tr_b16 v[96:97], v13 offset:0
    ds_read_b64_tr_b16 v[98:99], v13 offset:256
    ds_read_b64_tr_b16 v[100:101], v13 offset:1024
    ds_read_b64_tr_b16 v[102:103], v13 offset:1280
    s_waitcnt lgkmcnt(0)
    s_mov_b32 m0, 157696
    s_add_u32 s11, s10, 458752
    buffer_load_dwordx4 v9, s[4:7], s11 offen lds
    s_mov_b32 m0, 158720
    s_add_u32 s11, s10, 573440
    buffer_load_dwordx4 v9, s[4:7], s11 offen lds
    s_waitcnt vmcnt(2)
    ds_read_b64_tr_b16 v[104:105], v13 offset:2048
    ds_read_b64_tr_b16 v[106:107], v13 offset:2304
    ds_read_b64_tr_b16 v[108:109], v13 offset:3072
    ds_read_b64_tr_b16 v[110:111], v13 offset:3328
    s_waitcnt lgkmcnt(0)
    s_mov_b32 m0, 159744
    s_add_u32 s11, s10, 688128
    buffer_load_dwordx4 v9, s[4:7], s11 offen lds
    s_mov_b32 m0, 160768
    s_add_u32 s11, s10, 802816
    buffer_load_dwordx4 v9, s[4:7], s11 offen lds
    s_waitcnt vmcnt(2)
    ds_read_b64_tr_b16 v[112:113], v13 offset:0
    ds_read_b64_tr_b16 v[114:115], v13 offset:256
    ds_read_b64_tr_b16 v[116:117], v13 offset:1024
    ds_read_b64_tr_b16 v[118:119], v13 offset:1280
    s_waitcnt lgkmcnt(0)
    s_waitcnt vmcnt(0)
    ds_read_b64_tr_b16 v[120:121], v13 offset:2048
    ds_read_b64_tr_b16 v[122:123], v13 offset:2304
    ds_read_b64_tr_b16 v[124:125], v13 offset:3072
    ds_read_b64_tr_b16 v[126:127], v13 offset:3328
    s_waitcnt lgkmcnt(0)
    s_mul_i32 s10, s8, 147
    s_lshr_b32 s10, s10, 10
    s_mul_i32 s11, s10, 7
    s_sub_u32 s11, s8, s11
    s_mul_i32 s10, s10, 224*1024
    s_lshl_b32 s11, s11, 11
    s_add_u32 s10, s10, s11
    s_add_u32 s10, s10, s9
    s_add_u32 s10, s10, 23068672
    buffer_store_dwordx4 v[96:99], v4, s[52:55], s10 offen offset:0 sc1
    s_sleep 2
    buffer_store_dwordx4 v[100:103], v4, s[52:55], s10 offen offset:1024 sc1
    s_add_u32 s10, s10, 28*1024
    s_sleep 2
    buffer_store_dwordx4 v[104:107], v4, s[52:55], s10 offen offset:0 sc1
    s_sleep 2
    buffer_store_dwordx4 v[108:111], v4, s[52:55], s10 offen offset:1024 sc1
    s_add_u32 s10, s10, 28*1024
    s_sleep 2
    buffer_store_dwordx4 v[112:115], v4, s[52:55], s10 offen offset:0 sc1
    s_sleep 2
    buffer_store_dwordx4 v[116:119], v4, s[52:55], s10 offen offset:1024 sc1
    s_add_u32 s10, s10, 28*1024
    s_sleep 2
    buffer_store_dwordx4 v[120:123], v4, s[52:55], s10 offen offset:0 sc1
    s_sleep 2
    buffer_store_dwordx4 v[124:127], v4, s[52:55], s10 offen offset:1024 sc1
    s_add_u32 s10, s10, 28*1024
    s_sleep 2
    s_mov_b32 s10, 991232
    s_mov_b32 s95, 0x20000
    s_waitcnt vmcnt(0)
    buffer_load_dwordx2 v[160:161], v22, s[52:55], s10 offen sc1
    s_sleep 8
POLL_23:
    buffer_load_dwordx2 v[162:163], v22, s[52:55], s10 offen sc1
    s_waitcnt vmcnt(1)
    v_cmp_ne_u64 vcc, s[100:101], v[160:161]
    s_nop 0
    s_and_b64 exec, exec, vcc
    s_cbranch_scc0 POLLE_24
    s_sleep 8
    buffer_load_dwordx2 v[160:161], v22, s[52:55], s10 offen sc1
    s_waitcnt vmcnt(1)
    v_cmp_ne_u64 vcc, s[100:101], v[162:163]
    s_nop 0
    s_and_b64 exec, exec, vcc
    s_cbranch_scc0 POLLE_24
    s_sleep 8
    s_sub_u32 s95, s95, 1
    s_cmp_lg_u32 s95, 0
    s_cbranch_scc1 POLL_23
POLLE_24:
    s_mov_b64 exec, -1
    buffer_load_dwordx4 v[32:35], v21, s[52:55], 0 offen offset:0 sc1
    buffer_load_dwordx4 v[36:39], v21, s[52:55], 0 offen offset:64 sc1
    buffer_load_dwordx4 v[40:43], v21, s[52:55], 0 offen offset:128 sc1
    buffer_load_dwordx4 v[44:47], v21, s[52:55], 0 offen offset:192 sc1
    buffer_load_dwordx4 v[48:51], v21, s[52:55], 0 offen offset:256 sc1
    buffer_load_dwordx4 v[52:55], v21, s[52:55], 0 offen offset:320 sc1
    buffer_load_dwordx4 v[56:59], v21, s[52:55], 0 offen offset:384 sc1
    buffer_load_dwordx4 v[60:63], v21, s[52:55], 0 offen offset:448 sc1
    s_waitcnt vmcnt(0)
    s_setprio 2
    v_mfma_f32_16x16x32_bf16 v[16:19], v[32:35], v[96:99], v[16:19]
    v_mfma_f32_16x16x32_bf16 v[16:19], v[36:39], v[100:103], v[16:19]
    v_mfma_f32_16x16x32_bf16 v[16:19], v[40:43], v[104:107], v[16:19]
    v_mfma_f32_16x16x32_bf16 v[16:19], v[44:47], v[108:111], v[16:19]
    v_mfma_f32_16x16x32_bf16 v[16:19], v[48:51], v[112:115], v[16:19]
    v_mfma_f32_16x16x32_bf16 v[16:19], v[52:55], v[116:119], v[16:19]
    v_mfma_f32_16x16x32_bf16 v[16:19], v[56:59], v[120:123], v[16:19]
    v_mfma_f32_16x16x32_bf16 v[16:19], v[60:63], v[124:127], v[16:19]
    v_mov_b32 v10, 161792
    s_mov_b32 s95, 0x400000
LW_25:
    ds_read_b32 v11, v10 offset:28
    s_waitcnt lgkmcnt(0)
    v_cmp_eq_u32 vcc, 1, v11
    s_cbranch_vccnz LWE_26
    s_sub_u32 s95, s95, 1
    s_cmp_eq_u32 s95, 0
    s_cbranch_scc1 LWE_26
    s_sleep 4
    s_branch LW_25
LWE_26:
    v_add_u32 v10, 153600, v23
    ds_read_b64 v[12:13], v10
    s_waitcnt lgkmcnt(0)
    v_add_f32 v16, v16, v12
    v_add_f32 v17, v17, v13
    s_lshl_b32 s10, s8, 7
    s_add_u32 s10, s10, s9
    s_add_u32 s10, s10, 32768
    v_cvt_pk_bf16_f32 v6, v16, v17
    v_lshlrev_b32 v10, 16, v6
    v_and_b32 v11, 0xffff0000, v6
    v_sub_f32 v12, v16, v10
    v_sub_f32 v13, v17, v11
    v_cvt_pk_bf16_f32 v14, v10, v12
    v_cvt_pk_bf16_f32 v15, v11, v13
    s_mov_b64 exec, 0xffff
    buffer_store_dwordx2 v[14:15], v23, s[52:55], s10 offen sc1
    s_mov_b64 exec, -1
    s_waitcnt vmcnt(0)
    s_lshl_b32 s10, s14, 2
    s_add_u32 s10, s10, 6144
    s_lshl_b32 s10, s10, 6
    s_add_u32 s10, s10, 524288
    v_mov_b32 v6, s100
    v_mov_b32 v7, s101
    v_lshlrev_b32 v8, 19, v1
    s_mov_b64 exec, 1
    buffer_store_dwordx2 v[6:7], v8, s[52:55], s10 offen sc1
    s_mov_b64 exec, -1
    s_branch P3_LENE
P3_LEND:
    s_cmp_eq_u32 s60, 9
    s_cbranch_scc0 P3_LENE
    v_mov_b32 v10, 161792
    s_mov_b32 s95, 0x400000
LW_27:
    ds_read_b32 v11, v10 offset:16
    s_waitcnt lgkmcnt(0)
    v_cmp_eq_u32 vcc, 4, v11
    s_cbranch_vccnz LWE_28
    s_sub_u32 s95, s95, 1
    s_cmp_eq_u32 s95, 0
    s_cbranch_scc1 LWE_28
    s_sleep 8
    s_branch LW_27
LWE_28:
    s_lshr_b32 s4, s2, 3
    s_cmp_ge_u32 s4, 3
    s_cbranch_scc1 P3_NORT
    s_getpc_b64 s[8:9]
RTPC_29:
    s_add_u32 s8, s8, P3_NORT-RTPC_29
    s_addc_u32 s9, s9, 0
    s_lshl_b32 s10, s4, 13
    v_lshl_add_u32 v30, v1, 7, s10
    v_min_u32 v30, CODE_END-P3_NORT-4, v30
    global_load_dword v31, v30, s[8:9]
P3_NORT:
    s_bfe_u32 s4, s2, 0x30003
    s_lshl_b32 s4, s4, 7
    s_mov_b32 s5, 0
P3_WO:
    s_mov_b32 m0, s5
    s_add_u32 s5, s5, 4096
    buffer_load_dwordx4 v20, s[36:39], s4 offen offset:0 lds
    buffer_load_dwordx4 v21, s[36:39], s4 offen offset:1024 lds
    buffer_load_dwordx4 v22, s[36:39], s4 offen offset:2048 lds
    buffer_load_dwordx4 v23, s[36:39], s4 offen offset:3072 lds
    s_add_u32 s4, s4, 32768
    s_cmp_eq_u32 s5, 32768
    s_cselect_b32 s5, 65536, s5
    s_waitcnt vmcnt(32)
    s_cmp_lg_u32 s5, 98304
    s_cbranch_scc1 P3_WO
P3_LENE:
    v_mov_b32 v10, 161792
    s_mov_b32 s95, 0x400000
LW_30:
    ds_read_b32 v11, v10 offset:24
    s_waitcnt lgkmcnt(0)
    v_cmp_eq_u32 vcc, 1, v11
    s_cbranch_vccnz LWE_31
    s_sub_u32 s95, s95, 1
    s_cmp_eq_u32 s95, 0
    s_cbranch_scc1 LWE_31
    s_sleep 8
    s_branch LW_30
LWE_31:
    s_sub_u32 s5, s60, 8
    s_bfe_u32 s4, s2, 0x30003
    s_and_b32 s6, s5, 1
    s_lshl1_add_u32 s4, s4, s6
    s_lshr_b32 s6, s5, 1
    s_lshl2_add_u32 s4, s4, s6
    s_mul_i32 s4, s4, 28*1024
    s_add_u32 s4, s4, 20971520
    v_and_b32 v12, 48, v1
    v_add_u32 v12, v12, v1
    v_lshlrev_b32 v12, 4, v12
    v_lshl_add_u32 v10, s5, 2, v10
    s_mov_b32 s95, 0x400000
LW_32:
    ds_read_b32 v11, v10 offset:32
    s_waitcnt lgkmcnt(0)
    v_cmp_eq_u32 vcc, 1, v11
    s_cbranch_vccnz LWE_33
    s_sub_u32 s95, s95, 1
    s_cmp_eq_u32 s95, 0
    s_cbranch_scc1 LWE_33
    s_sleep 6
    s_branch LW_32
LWE_33:
    s_add_u32 s94, s4, 0
    buffer_load_dwordx4 v[56:59], v12, s[52:55], s94 offen offset:0 sc1
    buffer_load_dwordx4 v[60:63], v12, s[52:55], s94 offen offset:256 sc1
    buffer_load_dwordx4 v[64:67], v12, s[52:55], s94 offen offset:2048 sc1
    buffer_load_dwordx4 v[68:71], v12, s[52:55], s94 offen offset:2304 sc1
    s_sleep 1
    s_add_u32 s94, s4, 4096
    buffer_load_dwordx4 v[72:75], v12, s[52:55], s94 offen offset:0 sc1
    buffer_load_dwordx4 v[76:79], v12, s[52:55], s94 offen offset:256 sc1
    buffer_load_dwordx4 v[80:83], v12, s[52:55], s94 offen offset:2048 sc1
    buffer_load_dwordx4 v[84:87], v12, s[52:55], s94 offen offset:2304 sc1
    s_sleep 1
    s_add_u32 s94, s4, 8192
    buffer_load_dwordx4 v[88:91], v12, s[52:55], s94 offen offset:0 sc1
    buffer_load_dwordx4 v[92:95], v12, s[52:55], s94 offen offset:256 sc1
    buffer_load_dwordx4 v[96:99], v12, s[52:55], s94 offen offset:2048 sc1
    buffer_load_dwordx4 v[100:103], v12, s[52:55], s94 offen offset:2304 sc1
    s_sleep 1
    s_add_u32 s94, s4, 12288
    buffer_load_dwordx4 v[104:107], v12, s[52:55], s94 offen offset:0 sc1
    buffer_load_dwordx4 v[108:111], v12, s[52:55], s94 offen offset:256 sc1
    buffer_load_dwordx4 v[112:115], v12, s[52:55], s94 offen offset:2048 sc1
    buffer_load_dwordx4 v[116:119], v12, s[52:55], s94 offen offset:2304 sc1
    s_sleep 1
    s_add_u32 s94, s4, 16384
    buffer_load_dwordx4 v[120:123], v12, s[52:55], s94 offen offset:0 sc1
    buffer_load_dwordx4 v[124:127], v12, s[52:55], s94 offen offset:256 sc1
    buffer_load_dwordx4 v[128:131], v12, s[52:55], s94 offen offset:2048 sc1
    buffer_load_dwordx4 v[132:135], v12, s[52:55], s94 offen offset:2304 sc1
    s_sleep 1
    s_add_u32 s94, s4, 20480
    buffer_load_dwordx4 v[136:139], v12, s[52:55], s94 offen offset:0 sc1
    buffer_load_dwordx4 v[140:143], v12, s[52:55], s94 offen offset:256 sc1
    buffer_load_dwordx4 v[144:147], v12, s[52:55], s94 offen offset:2048 sc1
    buffer_load_dwordx4 v[148:151], v12, s[52:55], s94 offen offset:2304 sc1
    s_sleep 1
    s_add_u32 s94, s4, 24576
    buffer_load_dwordx4 v[152:155], v12, s[52:55], s94 offen offset:0 sc1
    buffer_load_dwordx4 v[156:159], v12, s[52:55], s94 offen offset:256 sc1
    buffer_load_dwordx4 v[160:163], v12, s[52:55], s94 offen offset:2048 sc1
    buffer_load_dwordx4 v[164:167], v12, s[52:55], s94 offen offset:2304 sc1
    s_sleep 1
P3_NOWF:
    s_setprio 3
    s_lshl_b32 s20, s26, 7
    s_lshl_b32 s21, s25, 2
    s_add_u32 s20, s20, s21
    s_add_u32 s20, s20, 1024
    s_waitcnt vmcnt(0) lgkmcnt(0)
    s_lshl_b32 s20, s20, 6
    s_add_u32 s20, s20, 524288
    v_mov_b32 v4, s100
    v_mov_b32 v5, s101
    v_lshlrev_b32 v6, 19, v1
    s_cmp_eq_u32 s60, 8
    s_cselect_b64 exec, 1, 0
    s_barrier
    buffer_store_dwordx2 v[4:5], v6, s[52:55], s20 offen sc1
    s_mov_b64 exec, -1
P3_END:
    s_bfe_u32 s25, s2, 0x30003
    s_and_b32 s26, s2, 7
    s_lshl_b32 s26, s26, 2
    s_lshr_b32 s27, s2, 6
    s_add_u32 s26, s26, s27
    s_cmp_ge_u32 s60, 8
    s_cbranch_scc1 P4_LOADER
    s_cmp_ge_u32 s60, 4
    s_cbranch_scc1 P4_IDLE
    s_mov_b32 s95, 0x400000
LW_34:
    ds_read_b32 v3, v0 offset:20
    s_waitcnt lgkmcnt(0)
    v_cmp_eq_u32 vcc, 1, v3
    s_cbranch_vccnz LWE_35
    s_sub_u32 s95, s95, 1
    s_cmp_eq_u32 s95, 0
    s_cbranch_scc1 LWE_35
    s_sleep 2
    s_branch LW_34
LWE_35:
    ds_read_b64 v[2:3], v0 offset:48
    s_waitcnt vmcnt(0) lgkmcnt(0)
    s_barrier
    v_readfirstlane_b32 s100, v2
    v_readfirstlane_b32 s101, v3
    s_and_b32 s23, s60, 1
    s_lshr_b32 s24, s60, 1
    v_lshrrev_b32 v4, 5, v1
    v_lshlrev_b32 v12, 4, v4
    s_lshl_b32 s8, s25, 8
    s_lshl_b32 s9, s24, 7
    s_add_u32 s9, s9, s8
    s_add_u32 s9, s9, 4096
    s_add_u32 s10, s9, 4096
    s_waitcnt vmcnt(0)
    buffer_load_dwordx4 v[72:75], v12, s[52:55], s9 offen offset:0 sc1
    buffer_load_dwordx4 v[76:79], v12, s[52:55], s9 offen offset:32 sc1
    buffer_load_dwordx4 v[80:83], v12, s[52:55], s9 offen offset:64 sc1
    buffer_load_dwordx4 v[84:87], v12, s[52:55], s9 offen offset:96 sc1
    buffer_load_dwordx4 v[128:131], v12, s[52:55], s10 offen offset:0 sc1
    buffer_load_dwordx4 v[132:135], v12, s[52:55], s10 offen offset:32 sc1
    buffer_load_dwordx4 v[136:139], v12, s[52:55], s10 offen offset:64 sc1
    buffer_load_dwordx4 v[140:143], v12, s[52:55], s10 offen offset:96 sc1
    v_and_b32 v3, 31, v1
    s_lshl_b32 s4, s26, 16
    s_lshl_b32 s5, s23, 15
    s_add_u32 s4, s4, s5
    s_lshl_b32 s5, s25, 12
    s_add_u32 s4, s4, s5
    s_lshl_b32 s5, s24, 11
    s_add_u32 s4, s4, s5
    s_add_u32 s5, s4, 11534336
    s_lshl_b32 s6, s26, 9
    s_lshl_b32 s7, s23, 8
    s_add_u32 s6, s6, s7
    s_lshl_b32 s7, s25, 15
    s_add_u32 s6, s6, s7
    s_lshl_b32 s7, s24, 14
    s_add_u32 s6, s6, s7
    s_add_u32 s6, s6, 65536
    v_lshlrev_b32 v16, 4, v1
    s_lshl_b32 s20, s23, 12
    v_add_u32 v16, s20, v16
    v_lshrrev_b32 v25, 5, v1
    v_bfe_u32 v24, v1, 2, 2
    v_lshl_add_u32 v26, v25, 2, v24
    v_lshlrev_b32 v20, 7, v26
    v_lshrrev_b32 v24, 1, v24
    v_xor_b32 v24, s24, v24
    v_lshl_add_u32 v20, v24, 6, v20
    v_bfe_u32 v24, v1, 4, 1
    v_lshl_add_u32 v20, v24, 5, v20
    v_and_b32 v24, 3, v1
    v_lshl_add_u32 v20, v24, 3, v20
    v_add_u32 v20, 8192, v20
    v_add_u32 v17, 65536, v16
    v_add_u32 v21, 65536, v20
    v_add_u32 v16, 32768, v16
    v_add_u32 v17, 32768, v17
    v_subrev_u32 v20, 8192, v20
    v_subrev_u32 v21, 8192, v21
    v_lshlrev_b32 v5, 4, v1
    v_lshlrev_b32 v6, 3, v3
    v_lshl_add_u32 v6, v4, 2, v6
    s_mov_b32 s7, 0x3f803f80
    v_lshlrev_b32 v88, 16, v160
    v_and_b32 v89, 0xffff0000, v160
    v_lshlrev_b32 v90, 16, v161
    v_and_b32 v91, 0xffff0000, v161
    v_lshlrev_b32 v92, 16, v162
    v_and_b32 v93, 0xffff0000, v162
    v_lshlrev_b32 v94, 16, v163
    v_and_b32 v95, 0xffff0000, v163
    v_lshlrev_b32 v96, 16, v164
    v_and_b32 v97, 0xffff0000, v164
    v_lshlrev_b32 v98, 16, v165
    v_and_b32 v99, 0xffff0000, v165
    v_lshlrev_b32 v100, 16, v166
    v_and_b32 v101, 0xffff0000, v166
    v_lshlrev_b32 v102, 16, v167
    v_and_b32 v103, 0xffff0000, v167
    ds_read_b64_tr_b16 v[104:105], v20 offset:0
    ds_read_b64_tr_b16 v[106:107], v20 offset:1024
    ds_read_b64_tr_b16 v[108:109], v20 offset:2048
    ds_read_b64_tr_b16 v[110:111], v20 offset:3072
    ds_read_b64_tr_b16 v[112:113], v20 offset:4096
    ds_read_b64_tr_b16 v[114:115], v20 offset:5120
    ds_read_b64_tr_b16 v[116:117], v20 offset:6144
    ds_read_b64_tr_b16 v[118:119], v20 offset:7168
    ds_read_b64_tr_b16 v[120:121], v20 offset:8192
    ds_read_b64_tr_b16 v[122:123], v20 offset:9216
    s_waitcnt lgkmcnt(4)
    ds_read_b64_tr_b16 v[124:125], v20 offset:10240
    ds_read_b64_tr_b16 v[126:127], v20 offset:11264
    ds_read_b64_tr_b16 v[152:153], v20 offset:12288
    ds_read_b64_tr_b16 v[154:155], v20 offset:13312
    ds_read_b64_tr_b16 v[156:157], v20 offset:14336
    ds_read_b64_tr_b16 v[158:159], v20 offset:15360
    s_waitcnt lgkmcnt(0)
    s_barrier
    ds_read_b128 v[48:51], v16 offset:0
    ds_read_b128 v[52:55], v16 offset:1024
    ds_read_b128 v[56:59], v16 offset:2048
    ds_read_b128 v[60:63], v16 offset:3072
    ds_read_b128 v[64:67], v16 offset:8192
    ds_read_b128 v[68:71], v16 offset:9216
    ds_read_b128 v[144:147], v16 offset:10240
    ds_read_b128 v[148:151], v16 offset:11264
    s_waitcnt lgkmcnt(7)
    v_mfma_f32_32x32x16_bf16 v[32:47], v[104:107], v[48:51], 0
    ds_read_b64_tr_b16 v[104:105], v20 offset:16384
    ds_read_b64_tr_b16 v[106:107], v20 offset:17408
    s_waitcnt lgkmcnt(8)
    v_mfma_f32_32x32x16_bf16 v[32:47], v[108:111], v[52:55], v[32:47]
    ds_read_b64_tr_b16 v[108:109], v20 offset:18432
    ds_read_b64_tr_b16 v[110:111], v20 offset:19456
    s_waitcnt lgkmcnt(9)
    v_mfma_f32_32x32x16_bf16 v[32:47], v[112:115], v[56:59], v[32:47]
    ds_read_b64_tr_b16 v[112:113], v20 offset:20480
    ds_read_b64_tr_b16 v[114:115], v20 offset:21504
    s_waitcnt lgkmcnt(10)
    v_mfma_f32_32x32x16_bf16 v[32:47], v[116:119], v[60:63], v[32:47]
    ds_read_b64_tr_b16 v[116:117], v20 offset:22528
    ds_read_b64_tr_b16 v[118:119], v20 offset:23552
    s_waitcnt lgkmcnt(11)
    v_mfma_f32_32x32x16_bf16 v[32:47], v[120:123], v[64:67], v[32:47]
    ds_read_b64_tr_b16 v[120:121], v20 offset:24576
    ds_read_b64_tr_b16 v[122:123], v20 offset:25600
    s_waitcnt lgkmcnt(12)
    v_mfma_f32_32x32x16_bf16 v[32:47], v[124:127], v[68:71], v[32:47]
    ds_read_b64_tr_b16 v[124:125], v20 offset:26624
    ds_read_b64_tr_b16 v[126:127], v20 offset:27648
    s_waitcnt lgkmcnt(13)
    v_mfma_f32_32x32x16_bf16 v[32:47], v[152:155], v[144:147], v[32:47]
    ds_read_b64_tr_b16 v[152:153], v20 offset:28672
    ds_read_b64_tr_b16 v[154:155], v20 offset:29696
    s_waitcnt lgkmcnt(14)
    v_mfma_f32_32x32x16_bf16 v[32:47], v[156:159], v[148:151], v[32:47]
    s_waitcnt lgkmcnt(5)
    s_barrier
    ds_read_b128 v[48:51], v16 offset:16384
    ds_read_b128 v[52:55], v16 offset:17408
    ds_read_b128 v[56:59], v16 offset:18432
    ds_read_b128 v[60:63], v16 offset:19456
    ds_read_b128 v[64:67], v16 offset:24576
    ds_read_b128 v[68:71], v16 offset:25600
    ds_read_b128 v[144:147], v16 offset:26624
    ds_read_b128 v[148:151], v16 offset:27648
    ds_read_b64_tr_b16 v[156:157], v20 offset:30720
    ds_read_b64_tr_b16 v[158:159], v20 offset:31744
    s_waitcnt lgkmcnt(9)
    v_mfma_f32_32x32x16_bf16 v[32:47], v[104:107], v[48:51], v[32:47]
    ds_read_b64_tr_b16 v[104:105], v21 offset:0
    ds_read_b64_tr_b16 v[106:107], v21 offset:1024
    s_waitcnt lgkmcnt(10)
    v_mfma_f32_32x32x16_bf16 v[32:47], v[108:111], v[52:55], v[32:47]
    ds_read_b64_tr_b16 v[108:109], v21 offset:2048
    ds_read_b64_tr_b16 v[110:111], v21 offset:3072
    s_waitcnt lgkmcnt(11)
    v_mfma_f32_32x32x16_bf16 v[32:47], v[112:115], v[56:59], v[32:47]
    ds_read_b64_tr_b16 v[112:113], v21 offset:4096
    ds_read_b64_tr_b16 v[114:115], v21 offset:5120
    s_waitcnt lgkmcnt(12)
    v_mfma_f32_32x32x16_bf16 v[32:47], v[116:119], v[60:63], v[32:47]
    ds_read_b64_tr_b16 v[116:117], v21 offset:6144
    ds_read_b64_tr_b16 v[118:119], v21 offset:7168
    s_waitcnt lgkmcnt(13)
    v_mfma_f32_32x32x16_bf16 v[32:47], v[120:123], v[64:67], v[32:47]
    ds_read_b64_tr_b16 v[120:121], v21 offset:8192
    ds_read_b64_tr_b16 v[122:123], v21 offset:9216
    s_waitcnt lgkmcnt(14)
    v_mfma_f32_32x32x16_bf16 v[32:47], v[124:127], v[68:71], v[32:47]
    s_waitcnt lgkmcnt(13)
    ds_read_b64_tr_b16 v[124:125], v21 offset:10240
    ds_read_b64_tr_b16 v[126:127], v21 offset:11264
    v_mfma_f32_32x32x16_bf16 v[32:47], v[152:155], v[144:147], v[32:47]
    s_waitcnt lgkmcnt(13)
    ds_read_b64_tr_b16 v[152:153], v21 offset:12288
    ds_read_b64_tr_b16 v[154:155], v21 offset:13312
    s_waitcnt lgkmcnt(14)
    v_mfma_f32_32x32x16_bf16 v[32:47], v[156:159], v[148:151], v[32:47]
    s_waitcnt lgkmcnt(5)
    s_barrier
    ds_read_b128 v[48:51], v17 offset:0
    ds_read_b128 v[52:55], v17 offset:1024
    ds_read_b128 v[56:59], v17 offset:2048
    ds_read_b128 v[60:63], v17 offset:3072
    ds_read_b128 v[64:67], v17 offset:8192
    ds_read_b128 v[68:71], v17 offset:9216
    ds_read_b128 v[144:147], v17 offset:10240
    ds_read_b128 v[148:151], v17 offset:11264
    ds_read_b64_tr_b16 v[156:157], v21 offset:14336
    ds_read_b64_tr_b16 v[158:159], v21 offset:15360
    s_waitcnt lgkmcnt(9)
    v_mfma_f32_32x32x16_bf16 v[32:47], v[104:107], v[48:51], v[32:47]
    ds_read_b64_tr_b16 v[104:105], v21 offset:16384
    ds_read_b64_tr_b16 v[106:107], v21 offset:17408
    s_waitcnt lgkmcnt(10)
    v_mfma_f32_32x32x16_bf16 v[32:47], v[108:111], v[52:55], v[32:47]
    ds_read_b64_tr_b16 v[108:109], v21 offset:18432
    ds_read_b64_tr_b16 v[110:111], v21 offset:19456
    s_waitcnt lgkmcnt(11)
    v_mfma_f32_32x32x16_bf16 v[32:47], v[112:115], v[56:59], v[32:47]
    ds_read_b64_tr_b16 v[112:113], v21 offset:20480
    ds_read_b64_tr_b16 v[114:115], v21 offset:21504
    s_waitcnt lgkmcnt(12)
    v_mfma_f32_32x32x16_bf16 v[32:47], v[116:119], v[60:63], v[32:47]
    ds_read_b64_tr_b16 v[116:117], v21 offset:22528
    ds_read_b64_tr_b16 v[118:119], v21 offset:23552
    s_waitcnt lgkmcnt(13)
    v_mfma_f32_32x32x16_bf16 v[32:47], v[120:123], v[64:67], v[32:47]
    ds_read_b64_tr_b16 v[120:121], v21 offset:24576
    ds_read_b64_tr_b16 v[122:123], v21 offset:25600
    s_waitcnt lgkmcnt(14)
    v_mfma_f32_32x32x16_bf16 v[32:47], v[124:127], v[68:71], v[32:47]
    s_waitcnt lgkmcnt(13)
    ds_read_b64_tr_b16 v[124:125], v21 offset:26624
    ds_read_b64_tr_b16 v[126:127], v21 offset:27648
    v_mfma_f32_32x32x16_bf16 v[32:47], v[152:155], v[144:147], v[32:47]
    s_waitcnt lgkmcnt(13)
    ds_read_b64_tr_b16 v[152:153], v21 offset:28672
    ds_read_b64_tr_b16 v[154:155], v21 offset:29696
    s_waitcnt lgkmcnt(14)
    v_mfma_f32_32x32x16_bf16 v[32:47], v[156:159], v[148:151], v[32:47]
    s_waitcnt lgkmcnt(5)
    s_barrier
    ds_read_b128 v[48:51], v17 offset:16384
    ds_read_b128 v[52:55], v17 offset:17408
    ds_read_b128 v[56:59], v17 offset:18432
    ds_read_b128 v[60:63], v17 offset:19456
    ds_read_b128 v[64:67], v17 offset:24576
    ds_read_b128 v[68:71], v17 offset:25600
    ds_read_b128 v[144:147], v17 offset:26624
    ds_read_b128 v[148:151], v17 offset:27648
    ds_read_b64_tr_b16 v[156:157], v21 offset:30720
    ds_read_b64_tr_b16 v[158:159], v21 offset:31744
    s_waitcnt lgkmcnt(9)
    v_mfma_f32_32x32x16_bf16 v[32:47], v[104:107], v[48:51], v[32:47]
    s_waitcnt lgkmcnt(8)
    v_mfma_f32_32x32x16_bf16 v[32:47], v[108:111], v[52:55], v[32:47]
    s_waitcnt lgkmcnt(7)
    v_mfma_f32_32x32x16_bf16 v[32:47], v[112:115], v[56:59], v[32:47]
    s_waitcnt lgkmcnt(6)
    v_mfma_f32_32x32x16_bf16 v[32:47], v[116:119], v[60:63], v[32:47]
    s_waitcnt lgkmcnt(5)
    v_mfma_f32_32x32x16_bf16 v[32:47], v[120:123], v[64:67], v[32:47]
    s_waitcnt lgkmcnt(4)
    v_mfma_f32_32x32x16_bf16 v[32:47], v[124:127], v[68:71], v[32:47]
    s_waitcnt lgkmcnt(3)
    v_mfma_f32_32x32x16_bf16 v[32:47], v[152:155], v[144:147], v[32:47]
    s_waitcnt lgkmcnt(0) vmcnt(0)
    v_mfma_f32_32x32x16_bf16 v[32:47], v[156:159], v[148:151], v[32:47]
    s_nop 11
    v_pk_fma_f32 v[88:89], v[72:73], v[32:33], v[88:89]
    v_pk_fma_f32 v[90:91], v[74:75], v[34:35], v[90:91]
    v_pk_fma_f32 v[92:93], v[76:77], v[36:37], v[92:93]
    v_pk_fma_f32 v[94:95], v[78:79], v[38:39], v[94:95]
    v_pk_fma_f32 v[96:97], v[80:81], v[40:41], v[96:97]
    v_pk_fma_f32 v[98:99], v[82:83], v[42:43], v[98:99]
    v_pk_fma_f32 v[100:101], v[84:85], v[44:45], v[100:101]
    v_pk_fma_f32 v[102:103], v[86:87], v[46:47], v[102:103]
    v_pk_mul_f32 v[128:129], v[128:129], v[88:89]
    v_pk_mul_f32 v[130:131], v[130:131], v[90:91]
    v_pk_mul_f32 v[132:133], v[132:133], v[92:93]
    v_pk_mul_f32 v[134:135], v[134:135], v[94:95]
    v_cvt_pk_bf16_f32 v72, v128, v129
    v_cvt_pk_bf16_f32 v73, v130, v131
    v_cvt_pk_bf16_f32 v74, v132, v133
    v_cvt_pk_bf16_f32 v75, v134, v135
    buffer_store_dwordx4 v[72:75], v5, s[52:55], s5 offen offset:0 sc1
    v_pk_mul_f32 v[136:137], v[136:137], v[96:97]
    v_pk_mul_f32 v[138:139], v[138:139], v[98:99]
    v_pk_mul_f32 v[140:141], v[140:141], v[100:101]
    v_pk_mul_f32 v[142:143], v[142:143], v[102:103]
    v_cvt_pk_bf16_f32 v76, v136, v137
    v_cvt_pk_bf16_f32 v77, v138, v139
    v_cvt_pk_bf16_f32 v78, v140, v141
    v_cvt_pk_bf16_f32 v79, v142, v143
    buffer_store_dwordx4 v[76:79], v5, s[52:55], s5 offen offset:1024 sc1
    v_cvt_pk_bf16_f32 v160, v88, v89
    v_cvt_pk_bf16_f32 v161, v90, v91
    v_cvt_pk_bf16_f32 v162, v92, v93
    v_cvt_pk_bf16_f32 v163, v94, v95
    v_cvt_pk_bf16_f32 v164, v96, v97
    v_cvt_pk_bf16_f32 v165, v98, v99
    v_cvt_pk_bf16_f32 v166, v100, v101
    v_cvt_pk_bf16_f32 v167, v102, v103
    v_dot2_f32_bf16 v56, v160, s7, 0
    v_dot2_f32_bf16 v57, v160, v160, 0
    v_dot2_f32_bf16 v56, v161, s7, v56
    v_dot2_f32_bf16 v57, v161, v161, v57
    v_dot2_f32_bf16 v56, v162, s7, v56
    v_dot2_f32_bf16 v57, v162, v162, v57
    v_dot2_f32_bf16 v56, v163, s7, v56
    v_dot2_f32_bf16 v57, v163, v163, v57
    v_dot2_f32_bf16 v56, v164, s7, v56
    v_dot2_f32_bf16 v57, v164, v164, v57
    v_dot2_f32_bf16 v56, v165, s7, v56
    v_dot2_f32_bf16 v57, v165, v165, v57
    v_dot2_f32_bf16 v56, v166, s7, v56
    v_dot2_f32_bf16 v57, v166, v166, v57
    v_dot2_f32_bf16 v56, v167, s7, v56
    v_dot2_f32_bf16 v57, v167, v167, v57
    s_nop 1
    v_mov_b32 v58, v56
    v_mov_b32 v59, v57
    s_nop 0
    v_permlane32_swap_b32 v56, v58
    v_permlane32_swap_b32 v57, v59
    v_add_f32 v56, v56, v58
    v_add_f32 v57, v57, v59
    s_nop 0
    v_mov_b32_dpp v58, v56 quad_perm:[1,1,3,3] row_mask:0xf bank_mask:0xf
    v_mov_b32_dpp v59, v57 quad_perm:[1,1,3,3] row_mask:0xf bank_mask:0xf
    s_mov_b64 exec, 0x55555555
    buffer_store_dwordx4 v[56:59], v6, s[52:55], s6 offen sc1
    s_mov_b64 exec, -1
    s_waitcnt vmcnt(1)
    s_barrier
    s_branch P4_END
P4_LOADER:
    s_setprio 3
    s_cmp_eq_u32 s60, 8
    s_cbranch_scc1 P4_LA0
    s_cmp_ge_u32 s60, 10
    s_cbranch_scc1 P4_IDLE
    s_branch P4_END
P4_IDLE:
    s_mov_b32 s61, 5
BAR_36:
    s_barrier
    s_sub_u32 s61, s61, 1
    s_cmp_lg_u32 s61, 0
    s_cbranch_scc1 BAR_36
    s_branch P4_END
P4_LA0:
    v_lshlrev_b32 v12, 4, v1
    s_lshl_b32 s4, s26, 16
    s_lshr_b32 s6, s26, 2
    s_lshl_b32 s6, s6, 7
    s_add_u32 s6, s6, 1024
    s_add_u32 s4, s4, 7340032
    s_mov_b32 s7, 32768
    s_mov_b32 s8, 8
    s_lshl_b32 s6, s6, 6
    s_add_u32 s6, s6, 524288
    v_min_u32 v14, 31, v1
    v_lshlrev_b32 v14, 8, v14
    s_mov_b32 s95, 0x20000
    s_waitcnt vmcnt(0)
    buffer_load_dwordx2 v[16:17], v14, s[52:55], s6 offen sc1
POLL_37:
    buffer_load_dwordx2 v[18:19], v14, s[52:55], s6 offen sc1
    s_waitcnt vmcnt(1)
    v_cmp_ne_u64 vcc, s[100:101], v[16:17]
    s_nop 0
    s_and_b64 exec, exec, vcc
    s_cbranch_scc0 POLLE_38
    buffer_load_dwordx2 v[16:17], v14, s[52:55], s6 offen sc1
    s_waitcnt vmcnt(1)
    v_cmp_ne_u64 vcc, s[100:101], v[18:19]
    s_nop 0
    s_and_b64 exec, exec, vcc
    s_cbranch_scc0 POLLE_38
    s_sub_u32 s95, s95, 1
    s_cmp_lg_u32 s95, 0
    s_cbranch_scc1 POLL_37
POLLE_38:
    s_mov_b64 exec, -1
    s_mov_b32 m0, 32768
    s_add_u32 s6, s4, 0
    buffer_load_dwordx4 v12, s[52:55], s6 offen offset:0 sc1 lds
    buffer_load_dwordx4 v12, s[52:55], s6 offen offset:1024 sc1 lds
    buffer_load_dwordx4 v12, s[52:55], s6 offen offset:2048 sc1 lds
    buffer_load_dwordx4 v12, s[52:55], s6 offen offset:3072 sc1 lds
    s_mov_b32 m0, 36864
    s_add_u32 s6, s4, 32768
    buffer_load_dwordx4 v12, s[52:55], s6 offen offset:0 sc1 lds
    buffer_load_dwordx4 v12, s[52:55], s6 offen offset:1024 sc1 lds
    buffer_load_dwordx4 v12, s[52:55], s6 offen offset:2048 sc1 lds
    buffer_load_dwordx4 v12, s[52:55], s6 offen offset:3072 sc1 lds
    s_mov_b32 m0, 40960
    s_add_u32 s6, s4, 4096
    buffer_load_dwordx4 v12, s[52:55], s6 offen offset:0 sc1 lds
    buffer_load_dwordx4 v12, s[52:55], s6 offen offset:1024 sc1 lds
    buffer_load_dwordx4 v12, s[52:55], s6 offen offset:2048 sc1 lds
    buffer_load_dwordx4 v12, s[52:55], s6 offen offset:3072 sc1 lds
    s_mov_b32 m0, 45056
    s_add_u32 s6, s4, 36864
    buffer_load_dwordx4 v12, s[52:55], s6 offen offset:0 sc1 lds
    buffer_load_dwordx4 v12, s[52:55], s6 offen offset:1024 sc1 lds
    buffer_load_dwordx4 v12, s[52:55], s6 offen offset:2048 sc1 lds
    buffer_load_dwordx4 v12, s[52:55], s6 offen offset:3072 sc1 lds
    s_mov_b32 m0, 49152
    s_add_u32 s6, s4, 8192
    buffer_load_dwordx4 v12, s[52:55], s6 offen offset:0 sc1 lds
    buffer_load_dwordx4 v12, s[52:55], s6 offen offset:1024 sc1 lds
    buffer_load_dwordx4 v12, s[52:55], s6 offen offset:2048 sc1 lds
    buffer_load_dwordx4 v12, s[52:55], s6 offen offset:3072 sc1 lds
    s_mov_b32 m0, 53248
    s_add_u32 s6, s4, 40960
    buffer_load_dwordx4 v12, s[52:55], s6 offen offset:0 sc1 lds
    buffer_load_dwordx4 v12, s[52:55], s6 offen offset:1024 sc1 lds
    buffer_load_dwordx4 v12, s[52:55], s6 offen offset:2048 sc1 lds
    buffer_load_dwordx4 v12, s[52:55], s6 offen offset:3072 sc1 lds
    s_mov_b32 m0, 57344
    s_add_u32 s6, s4, 12288
    buffer_load_dwordx4 v12, s[52:55], s6 offen offset:0 sc1 lds
    buffer_load_dwordx4 v12, s[52:55], s6 offen offset:1024 sc1 lds
    buffer_load_dwordx4 v12, s[52:55], s6 offen offset:2048 sc1 lds
    buffer_load_dwordx4 v12, s[52:55], s6 offen offset:3072 sc1 lds
    s_mov_b32 m0, 61440
    s_add_u32 s6, s4, 45056
    buffer_load_dwordx4 v12, s[52:55], s6 offen offset:0 sc1 lds
    buffer_load_dwordx4 v12, s[52:55], s6 offen offset:1024 sc1 lds
    buffer_load_dwordx4 v12, s[52:55], s6 offen offset:2048 sc1 lds
    buffer_load_dwordx4 v12, s[52:55], s6 offen offset:3072 sc1 lds
    s_mov_b32 m0, 98304
    s_add_u32 s6, s4, 16384
    buffer_load_dwordx4 v12, s[52:55], s6 offen offset:0 sc1 lds
    buffer_load_dwordx4 v12, s[52:55], s6 offen offset:1024 sc1 lds
    buffer_load_dwordx4 v12, s[52:55], s6 offen offset:2048 sc1 lds
    buffer_load_dwordx4 v12, s[52:55], s6 offen offset:3072 sc1 lds
    s_mov_b32 m0, 102400
    s_add_u32 s6, s4, 49152
    buffer_load_dwordx4 v12, s[52:55], s6 offen offset:0 sc1 lds
    buffer_load_dwordx4 v12, s[52:55], s6 offen offset:1024 sc1 lds
    buffer_load_dwordx4 v12, s[52:55], s6 offen offset:2048 sc1 lds
    buffer_load_dwordx4 v12, s[52:55], s6 offen offset:3072 sc1 lds
    s_waitcnt vmcnt(24)
    s_barrier
    s_mov_b32 m0, 106496
    s_add_u32 s6, s4, 20480
    buffer_load_dwordx4 v12, s[52:55], s6 offen offset:0 sc1 lds
    buffer_load_dwordx4 v12, s[52:55], s6 offen offset:1024 sc1 lds
    buffer_load_dwordx4 v12, s[52:55], s6 offen offset:2048 sc1 lds
    buffer_load_dwordx4 v12, s[52:55], s6 offen offset:3072 sc1 lds
    s_mov_b32 m0, 110592
    s_add_u32 s6, s4, 53248
    buffer_load_dwordx4 v12, s[52:55], s6 offen offset:0 sc1 lds
    buffer_load_dwordx4 v12, s[52:55], s6 offen offset:1024 sc1 lds
    buffer_load_dwordx4 v12, s[52:55], s6 offen offset:2048 sc1 lds
    buffer_load_dwordx4 v12, s[52:55], s6 offen offset:3072 sc1 lds
    s_mov_b32 m0, 114688
    s_add_u32 s6, s4, 24576
    buffer_load_dwordx4 v12, s[52:55], s6 offen offset:0 sc1 lds
    buffer_load_dwordx4 v12, s[52:55], s6 offen offset:1024 sc1 lds
    buffer_load_dwordx4 v12, s[52:55], s6 offen offset:2048 sc1 lds
    buffer_load_dwordx4 v12, s[52:55], s6 offen offset:3072 sc1 lds
    s_mov_b32 m0, 118784
    s_add_u32 s6, s4, 57344
    buffer_load_dwordx4 v12, s[52:55], s6 offen offset:0 sc1 lds
    buffer_load_dwordx4 v12, s[52:55], s6 offen offset:1024 sc1 lds
    buffer_load_dwordx4 v12, s[52:55], s6 offen offset:2048 sc1 lds
    buffer_load_dwordx4 v12, s[52:55], s6 offen offset:3072 sc1 lds
    s_waitcnt vmcnt(24)
    s_barrier
    s_mov_b32 m0, 122880
    s_add_u32 s6, s4, 28672
    buffer_load_dwordx4 v12, s[52:55], s6 offen offset:0 sc1 lds
    buffer_load_dwordx4 v12, s[52:55], s6 offen offset:1024 sc1 lds
    buffer_load_dwordx4 v12, s[52:55], s6 offen offset:2048 sc1 lds
    buffer_load_dwordx4 v12, s[52:55], s6 offen offset:3072 sc1 lds
    s_mov_b32 m0, 126976
    s_add_u32 s6, s4, 61440
    buffer_load_dwordx4 v12, s[52:55], s6 offen offset:0 sc1 lds
    buffer_load_dwordx4 v12, s[52:55], s6 offen offset:1024 sc1 lds
    buffer_load_dwordx4 v12, s[52:55], s6 offen offset:2048 sc1 lds
    buffer_load_dwordx4 v12, s[52:55], s6 offen offset:3072 sc1 lds
    s_waitcnt vmcnt(16)
    s_barrier
    s_waitcnt vmcnt(0)
    s_barrier
    s_lshr_b32 s4, s26, 1
    s_lshl_b32 s4, s4, 7
    s_and_b32 s5, s26, 1
    s_lshl_b32 s5, s5, 3
    s_add_u32 s5, s5, s25
    s_lshl_b32 s5, s5, 2
    s_add_u32 s4, s4, s5
    s_add_u32 s4, s4, 2048
    s_lshl_b32 s4, s4, 6
    s_add_u32 s4, s4, 524288
    v_mov_b32 v4, s100
    v_mov_b32 v5, s101
    v_lshlrev_b32 v6, 19, v1
    s_cmp_eq_u32 s60, 8
    s_cselect_b64 exec, 1, 0
    s_barrier
    buffer_store_dwordx2 v[4:5], v6, s[52:55], s4 offen sc1
    s_mov_b64 exec, -1
P4_END:
    s_mov_b32 s17, 0
    s_mov_b32 s16, 0
    s_bfe_u32 s25, s2, 0x30003
    s_and_b32 s21, s2, 1
    s_lshl3_add_u32 s25, s21, s25
    s_bfe_u32 s26, s2, 0x20001
    s_lshr_b32 s20, s2, 6
    s_lshl2_add_u32 s26, s26, s20
    s_cmp_ge_u32 s60, 8
    s_cbranch_scc1 P5_LOADER
    s_and_b32 s23, s60, 1
    s_bfe_u32 s24, s60, 0x10001
    s_lshl1_add_u32 s23, s23, s24
    s_mul_i32 s20, s24, 3
    s_add_u32 s21, s20, 1
    s_add_u32 s22, s20, 2
    s_cmp_ge_u32 s60, 4
    s_cselect_b32 s20, s20, s22
    s_cselect_b32 s21, s21, 6
    s_cselect_b64 vcc, 0, -1
    v_and_b32 v26, 15, v1
    v_and_b32 v7, 48, v1
    v_add_u32 v7, v7, v1
    v_lshlrev_b32 v7, 4, v7
    s_lshl_b32 s22, s23, 12
    s_add_u32 s22, s22, 32768
    v_add_u32 v7, s22, v7
    v_add_u32 v17, 65536, v7
    v_xor_b32 v6, 4096, v7
    v_xor_b32 v16, 4096, v17
    v_lshlrev_b32 v5, 4, v1
    s_lshl_b32 s22, s20, 11
    v_add_u32 v24, s22, v5
    v_add_u32 v20, 65536, v24
    v_add_u32 v18, 131072, v24
    s_lshl_b32 s22, s21, 11
    v_add_u32 v25, s22, v5
    v_add_u32 v23, 65536, v25
    v_add_u32 v21, 131072, v25
    v_mov_b32 v32, 0
    v_mov_b32 v33, 0
    v_mov_b32 v34, 0
    v_mov_b32 v35, 0
    v_mov_b32 v36, 0
    v_mov_b32 v37, 0
    v_mov_b32 v38, 0
    v_mov_b32 v39, 0
    v_mov_b32 v40, 0
    v_mov_b32 v41, 0
    v_mov_b32 v42, 0
    v_mov_b32 v43, 0
    v_mov_b32 v44, 0
    v_mov_b32 v45, 0
    v_mov_b32 v46, 0
    v_mov_b32 v47, 0
    v_mov_b32 v48, 0
    v_mov_b32 v49, 0
    v_mov_b32 v50, 0
    v_mov_b32 v51, 0
    v_mov_b32 v52, 0
    v_mov_b32 v53, 0
    v_mov_b32 v54, 0
    v_mov_b32 v55, 0
    v_mov_b32 v56, 0
    v_mov_b32 v57, 0
    v_mov_b32 v58, 0
    v_mov_b32 v59, 0
    v_mov_b32 v60, 0
    v_mov_b32 v61, 0
    v_mov_b32 v62, 0
    v_mov_b32 v63, 0
    v_mov_b32 v64, 0
    v_mov_b32 v65, 0
    v_mov_b32 v66, 0
    v_mov_b32 v67, 0
    v_mov_b32 v68, 0
    v_mov_b32 v69, 0
    v_mov_b32 v70, 0
    v_mov_b32 v71, 0
    v_mov_b32 v72, 0
    v_mov_b32 v73, 0
    v_mov_b32 v74, 0
    v_mov_b32 v75, 0
    v_mov_b32 v76, 0
    v_mov_b32 v77, 0
    v_mov_b32 v78, 0
    v_mov_b32 v79, 0
    v_mov_b32 v80, 0
    v_mov_b32 v81, 0
    v_mov_b32 v82, 0
    v_mov_b32 v83, 0
    v_mov_b32 v84, 0
    v_mov_b32 v85, 0
    v_mov_b32 v86, 0
    v_mov_b32 v87, 0
    v_mov_b32 v88, 0
    v_mov_b32 v89, 0
    v_mov_b32 v90, 0
    v_mov_b32 v91, 0
    v_mov_b32 v92, 0
    v_mov_b32 v93, 0
    v_mov_b32 v94, 0
    v_mov_b32 v95, 0
    v_lshlrev_b32 v19, 4, v26
    s_lshl_b32 s22, s23, 9
    s_add_u32 s22, s22, 114688
    v_add_u32 v19, s22, v19
    v_xor_b32 v22, 512, v19
    v_lshlrev_b32 v0, 3, v26
    s_lshl_b32 s22, s20, 7
    s_add_u32 s22, s22, 116736
    v_add_u32 v4, s22, v0
    s_lshl_b32 s22, s21, 7
    s_add_u32 s22, s22, 116736
    v_add_u32 v0, s22, v0
    s_mul_i32 s8, s25, 7
    s_lshl2_add_u32 s9, s26, s23
    s_mul_i32 s9, s9, 112
    s_add_u32 s9, s9, s8
    s_add_u32 s4, s9, s20
    s_lshl_b32 s4, s4, 10
    s_add_u32 s4, s4, 13631488
    s_add_u32 s5, s9, s21
    s_lshl_b32 s5, s5, 10
    s_add_u32 s5, s5, 13631488
    s_lshl2_add_u32 s9, s26, s23
    s_xor_b32 s9, s9, 1
    s_mul_i32 s9, s9, 112
    s_add_u32 s9, s9, s8
    s_add_u32 s6, s9, s20
    s_lshl_b32 s6, s6, 10
    s_add_u32 s6, s6, 13631488
    s_add_u32 s7, s9, s21
    s_lshl_b32 s7, s7, 10
    s_add_u32 s7, s7, 13631488
    v_mov_b32 v26, 0
    v_mov_b32 v27, 0
    v_mov_b32 v28, 0
    v_mov_b32 v29, 0
    v_mov_b32 v30, 0
    v_mov_b32 v31, 0
    v_mov_b32 v2, 0
    v_mov_b32 v3, 0
    s_waitcnt vmcnt(0)
    s_barrier
    ds_read_b128 v[96:99], v7 offset:0
    ds_read_b128 v[112:115], v18 offset:0
    ds_read_b128 v[100:103], v7 offset:256
    ds_read_b128 v[120:123], v18 offset:14336
    ds_read_b128 v[104:107], v6 offset:0
    ds_read_b128 v[108:111], v6 offset:256
    ds_read_b128 v[116:119], v21 offset:0
    ds_read_b128 v[124:127], v21 offset:14336
    s_waitcnt lgkmcnt(6)
    v_mfma_f32_16x16x32_bf16 v[32:35], v[112:115], v[96:99], v[32:35]
    ds_read_b128 v[128:131], v7 offset:2048
    s_waitcnt lgkmcnt(6)
    v_mfma_f32_16x16x32_bf16 v[36:39], v[112:115], v[100:103], v[36:39]
    ds_read_b128 v[144:147], v18 offset:1024
    s_waitcnt lgkmcnt(6)
    v_mfma_f32_16x16x32_bf16 v[64:67], v[120:123], v[96:99], v[64:67]
    ds_read_b128 v[132:135], v7 offset:2304
    v_mfma_f32_16x16x32_bf16 v[68:71], v[120:123], v[100:103], v[68:71]
    ds_read_b128 v[152:155], v18 offset:15360
    s_waitcnt lgkmcnt(7)
    v_mfma_f32_16x16x32_bf16 v[40:43], v[112:115], v[104:107], v[40:43]
    v_mfma_f32_16x16x32_bf16 v[72:75], v[120:123], v[104:107], v[72:75]
    ds_read_b128 v[136:139], v6 offset:2048
    s_waitcnt lgkmcnt(7)
    v_mfma_f32_16x16x32_bf16 v[44:47], v[112:115], v[108:111], v[44:47]
    ds_read_b128 v[140:143], v6 offset:2304
    v_mfma_f32_16x16x32_bf16 v[76:79], v[120:123], v[108:111], v[76:79]
    ds_read_b128 v[148:151], v21 offset:1024
    s_waitcnt lgkmcnt(8)
    v_mfma_f32_16x16x32_bf16 v[48:51], v[116:119], v[96:99], v[48:51]
    ds_read_b128 v[156:159], v21 offset:15360
    v_mfma_f32_16x16x32_bf16 v[52:55], v[116:119], v[100:103], v[52:55]
    s_waitcnt lgkmcnt(8)
    v_mfma_f32_16x16x32_bf16 v[80:83], v[124:127], v[96:99], v[80:83]
    v_mfma_f32_16x16x32_bf16 v[84:87], v[124:127], v[100:103], v[84:87]
    s_cbranch_vccnz P5_SK0
    v_mfma_f32_16x16x32_bf16 v[56:59], v[116:119], v[104:107], v[56:59]
    v_mfma_f32_16x16x32_bf16 v[60:63], v[116:119], v[108:111], v[60:63]
    v_mfma_f32_16x16x32_bf16 v[88:91], v[124:127], v[104:107], v[88:91]
    v_mfma_f32_16x16x32_bf16 v[92:95], v[124:127], v[108:111], v[92:95]
P5_SK0:
    s_waitcnt lgkmcnt(0)
    s_barrier
    v_mfma_f32_16x16x32_bf16 v[32:35], v[144:147], v[128:131], v[32:35]
    ds_read_b128 v[96:99], v7 offset:16384
    v_mfma_f32_16x16x32_bf16 v[36:39], v[144:147], v[132:135], v[36:39]
    ds_read_b128 v[112:115], v24 offset:0
    v_mfma_f32_16x16x32_bf16 v[64:67], v[152:155], v[128:131], v[64:67]
    ds_read_b128 v[100:103], v7 offset:16640
    v_mfma_f32_16x16x32_bf16 v[68:71], v[152:155], v[132:135], v[68:71]
    ds_read_b128 v[120:123], v24 offset:14336
    v_mfma_f32_16x16x32_bf16 v[40:43], v[144:147], v[136:139], v[40:43]
    v_mfma_f32_16x16x32_bf16 v[72:75], v[152:155], v[136:139], v[72:75]
    ds_read_b128 v[104:107], v6 offset:16384
    v_mfma_f32_16x16x32_bf16 v[44:47], v[144:147], v[140:143], v[44:47]
    ds_read_b128 v[108:111], v6 offset:16640
    v_mfma_f32_16x16x32_bf16 v[76:79], v[152:155], v[140:143], v[76:79]
    ds_read_b128 v[116:119], v25 offset:0
    v_mfma_f32_16x16x32_bf16 v[48:51], v[148:151], v[128:131], v[48:51]
    ds_read_b128 v[124:127], v25 offset:14336
    v_mfma_f32_16x16x32_bf16 v[52:55], v[148:151], v[132:135], v[52:55]
    v_mfma_f32_16x16x32_bf16 v[80:83], v[156:159], v[128:131], v[80:83]
    v_mfma_f32_16x16x32_bf16 v[84:87], v[156:159], v[132:135], v[84:87]
    s_cbranch_vccnz P5_SK1
    v_mfma_f32_16x16x32_bf16 v[56:59], v[148:151], v[136:139], v[56:59]
    v_mfma_f32_16x16x32_bf16 v[60:63], v[148:151], v[140:143], v[60:63]
    v_mfma_f32_16x16x32_bf16 v[88:91], v[156:159], v[136:139], v[88:91]
    v_mfma_f32_16x16x32_bf16 v[92:95], v[156:159], v[140:143], v[92:95]
P5_SK1:
    s_waitcnt lgkmcnt(6)
    v_mfma_f32_16x16x32_bf16 v[32:35], v[112:115], v[96:99], v[32:35]
    ds_read_b128 v[128:131], v7 offset:18432
    s_waitcnt lgkmcnt(6)
    v_mfma_f32_16x16x32_bf16 v[36:39], v[112:115], v[100:103], v[36:39]
    ds_read_b128 v[144:147], v24 offset:1024
    s_waitcnt lgkmcnt(6)
    v_mfma_f32_16x16x32_bf16 v[64:67], v[120:123], v[96:99], v[64:67]
    ds_read_b128 v[132:135], v7 offset:18688
    v_mfma_f32_16x16x32_bf16 v[68:71], v[120:123], v[100:103], v[68:71]
    ds_read_b128 v[152:155], v24 offset:15360
    s_waitcnt lgkmcnt(7)
    v_mfma_f32_16x16x32_bf16 v[40:43], v[112:115], v[104:107], v[40:43]
    v_mfma_f32_16x16x32_bf16 v[72:75], v[120:123], v[104:107], v[72:75]
    ds_read_b128 v[136:139], v6 offset:18432
    s_waitcnt lgkmcnt(7)
    v_mfma_f32_16x16x32_bf16 v[44:47], v[112:115], v[108:111], v[44:47]
    ds_read_b128 v[140:143], v6 offset:18688
    v_mfma_f32_16x16x32_bf16 v[76:79], v[120:123], v[108:111], v[76:79]
    ds_read_b128 v[148:151], v25 offset:1024
    s_waitcnt lgkmcnt(8)
    v_mfma_f32_16x16x32_bf16 v[48:51], v[116:119], v[96:99], v[48:51]
    ds_read_b128 v[156:159], v25 offset:15360
    v_mfma_f32_16x16x32_bf16 v[52:55], v[116:119], v[100:103], v[52:55]
    s_waitcnt lgkmcnt(8)
    v_mfma_f32_16x16x32_bf16 v[80:83], v[124:127], v[96:99], v[80:83]
    v_mfma_f32_16x16x32_bf16 v[84:87], v[124:127], v[100:103], v[84:87]
    s_cbranch_vccnz P5_SK2
    v_mfma_f32_16x16x32_bf16 v[56:59], v[116:119], v[104:107], v[56:59]
    v_mfma_f32_16x16x32_bf16 v[60:63], v[116:119], v[108:111], v[60:63]
    v_mfma_f32_16x16x32_bf16 v[88:91], v[124:127], v[104:107], v[88:91]
    v_mfma_f32_16x16x32_bf16 v[92:95], v[124:127], v[108:111], v[92:95]
P5_SK2:
    s_waitcnt lgkmcnt(0)
    s_barrier
    v_mfma_f32_16x16x32_bf16 v[32:35], v[144:147], v[128:131], v[32:35]
    ds_read_b128 v[96:99], v17 offset:0
    v_mfma_f32_16x16x32_bf16 v[36:39], v[144:147], v[132:135], v[36:39]
    ds_read_b128 v[112:115], v20 offset:0
    v_mfma_f32_16x16x32_bf16 v[64:67], v[152:155], v[128:131], v[64:67]
    ds_read_b128 v[100:103], v17 offset:256
    v_mfma_f32_16x16x32_bf16 v[68:71], v[152:155], v[132:135], v[68:71]
    ds_read_b128 v[120:123], v20 offset:14336
    v_mfma_f32_16x16x32_bf16 v[40:43], v[144:147], v[136:139], v[40:43]
    v_mfma_f32_16x16x32_bf16 v[72:75], v[152:155], v[136:139], v[72:75]
    ds_read_b128 v[104:107], v16 offset:0
    v_mfma_f32_16x16x32_bf16 v[44:47], v[144:147], v[140:143], v[44:47]
    ds_read_b128 v[108:111], v16 offset:256
    v_mfma_f32_16x16x32_bf16 v[76:79], v[152:155], v[140:143], v[76:79]
    ds_read_b128 v[116:119], v23 offset:0
    v_mfma_f32_16x16x32_bf16 v[48:51], v[148:151], v[128:131], v[48:51]
    ds_read_b128 v[124:127], v23 offset:14336
    v_mfma_f32_16x16x32_bf16 v[52:55], v[148:151], v[132:135], v[52:55]
    v_mfma_f32_16x16x32_bf16 v[80:83], v[156:159], v[128:131], v[80:83]
    v_mfma_f32_16x16x32_bf16 v[84:87], v[156:159], v[132:135], v[84:87]
    s_cbranch_vccnz P5_SK3
    v_mfma_f32_16x16x32_bf16 v[56:59], v[148:151], v[136:139], v[56:59]
    v_mfma_f32_16x16x32_bf16 v[60:63], v[148:151], v[140:143], v[60:63]
    v_mfma_f32_16x16x32_bf16 v[88:91], v[156:159], v[136:139], v[88:91]
    v_mfma_f32_16x16x32_bf16 v[92:95], v[156:159], v[140:143], v[92:95]
P5_SK3:
    s_waitcnt lgkmcnt(6)
    v_mfma_f32_16x16x32_bf16 v[32:35], v[112:115], v[96:99], v[32:35]
    ds_read_b128 v[128:131], v17 offset:2048
    s_waitcnt lgkmcnt(6)
    v_mfma_f32_16x16x32_bf16 v[36:39], v[112:115], v[100:103], v[36:39]
    ds_read_b128 v[144:147], v20 offset:1024
    s_waitcnt lgkmcnt(6)
    v_mfma_f32_16x16x32_bf16 v[64:67], v[120:123], v[96:99], v[64:67]
    ds_read_b128 v[132:135], v17 offset:2304
    v_mfma_f32_16x16x32_bf16 v[68:71], v[120:123], v[100:103], v[68:71]
    ds_read_b128 v[152:155], v20 offset:15360
    s_waitcnt lgkmcnt(7)
    v_mfma_f32_16x16x32_bf16 v[40:43], v[112:115], v[104:107], v[40:43]
    v_mfma_f32_16x16x32_bf16 v[72:75], v[120:123], v[104:107], v[72:75]
    ds_read_b128 v[136:139], v16 offset:2048
    s_waitcnt lgkmcnt(7)
    v_mfma_f32_16x16x32_bf16 v[44:47], v[112:115], v[108:111], v[44:47]
    ds_read_b128 v[140:143], v16 offset:2304
    v_mfma_f32_16x16x32_bf16 v[76:79], v[120:123], v[108:111], v[76:79]
    ds_read_b128 v[148:151], v23 offset:1024
    s_waitcnt lgkmcnt(8)
    v_mfma_f32_16x16x32_bf16 v[48:51], v[116:119], v[96:99], v[48:51]
    ds_read_b128 v[156:159], v23 offset:15360
    v_mfma_f32_16x16x32_bf16 v[52:55], v[116:119], v[100:103], v[52:55]
    s_waitcnt lgkmcnt(8)
    v_mfma_f32_16x16x32_bf16 v[80:83], v[124:127], v[96:99], v[80:83]
    v_mfma_f32_16x16x32_bf16 v[84:87], v[124:127], v[100:103], v[84:87]
    s_cbranch_vccnz P5_SK4
    v_mfma_f32_16x16x32_bf16 v[56:59], v[116:119], v[104:107], v[56:59]
    v_mfma_f32_16x16x32_bf16 v[60:63], v[116:119], v[108:111], v[60:63]
    v_mfma_f32_16x16x32_bf16 v[88:91], v[124:127], v[104:107], v[88:91]
    v_mfma_f32_16x16x32_bf16 v[92:95], v[124:127], v[108:111], v[92:95]
P5_SK4:
    s_waitcnt lgkmcnt(0)
    s_barrier
    v_mfma_f32_16x16x32_bf16 v[32:35], v[144:147], v[128:131], v[32:35]
    ds_read_b128 v[96:99], v7 offset:0
    v_mfma_f32_16x16x32_bf16 v[36:39], v[144:147], v[132:135], v[36:39]
    ds_read_b128 v[112:115], v18 offset:0
    v_mfma_f32_16x16x32_bf16 v[64:67], v[152:155], v[128:131], v[64:67]
    ds_read_b128 v[100:103], v7 offset:256
    v_mfma_f32_16x16x32_bf16 v[68:71], v[152:155], v[132:135], v[68:71]
    ds_read_b128 v[120:123], v18 offset:14336
    v_mfma_f32_16x16x32_bf16 v[40:43], v[144:147], v[136:139], v[40:43]
    v_mfma_f32_16x16x32_bf16 v[72:75], v[152:155], v[136:139], v[72:75]
    ds_read_b128 v[104:107], v6 offset:0
    v_mfma_f32_16x16x32_bf16 v[44:47], v[144:147], v[140:143], v[44:47]
    ds_read_b128 v[108:111], v6 offset:256
    v_mfma_f32_16x16x32_bf16 v[76:79], v[152:155], v[140:143], v[76:79]
    ds_read_b128 v[116:119], v21 offset:0
    v_mfma_f32_16x16x32_bf16 v[48:51], v[148:151], v[128:131], v[48:51]
    ds_read_b128 v[124:127], v21 offset:14336
    v_mfma_f32_16x16x32_bf16 v[52:55], v[148:151], v[132:135], v[52:55]
    v_mfma_f32_16x16x32_bf16 v[80:83], v[156:159], v[128:131], v[80:83]
    v_mfma_f32_16x16x32_bf16 v[84:87], v[156:159], v[132:135], v[84:87]
    s_cbranch_vccnz P5_SK5
    v_mfma_f32_16x16x32_bf16 v[56:59], v[148:151], v[136:139], v[56:59]
    v_mfma_f32_16x16x32_bf16 v[60:63], v[148:151], v[140:143], v[60:63]
    v_mfma_f32_16x16x32_bf16 v[88:91], v[156:159], v[136:139], v[88:91]
    v_mfma_f32_16x16x32_bf16 v[92:95], v[156:159], v[140:143], v[92:95]
P5_SK5:
    s_waitcnt lgkmcnt(6)
    v_mfma_f32_16x16x32_bf16 v[32:35], v[112:115], v[96:99], v[32:35]
    ds_read_b128 v[128:131], v7 offset:2048
    s_waitcnt lgkmcnt(6)
    v_mfma_f32_16x16x32_bf16 v[36:39], v[112:115], v[100:103], v[36:39]
    ds_read_b128 v[144:147], v18 offset:1024
    s_waitcnt lgkmcnt(6)
    v_mfma_f32_16x16x32_bf16 v[64:67], v[120:123], v[96:99], v[64:67]
    ds_read_b128 v[132:135], v7 offset:2304
    v_mfma_f32_16x16x32_bf16 v[68:71], v[120:123], v[100:103], v[68:71]
    ds_read_b128 v[152:155], v18 offset:15360
    s_waitcnt lgkmcnt(7)
    v_mfma_f32_16x16x32_bf16 v[40:43], v[112:115], v[104:107], v[40:43]
    v_mfma_f32_16x16x32_bf16 v[72:75], v[120:123], v[104:107], v[72:75]
    ds_read_b128 v[136:139], v6 offset:2048
    s_waitcnt lgkmcnt(7)
    v_mfma_f32_16x16x32_bf16 v[44:47], v[112:115], v[108:111], v[44:47]
    ds_read_b128 v[140:143], v6 offset:2304
    v_mfma_f32_16x16x32_bf16 v[76:79], v[120:123], v[108:111], v[76:79]
    ds_read_b128 v[148:151], v21 offset:1024
    s_waitcnt lgkmcnt(8)
    v_mfma_f32_16x16x32_bf16 v[48:51], v[116:119], v[96:99], v[48:51]
    ds_read_b128 v[156:159], v21 offset:15360
    v_mfma_f32_16x16x32_bf16 v[52:55], v[116:119], v[100:103], v[52:55]
    s_waitcnt lgkmcnt(8)
    v_mfma_f32_16x16x32_bf16 v[80:83], v[124:127], v[96:99], v[80:83]
    v_mfma_f32_16x16x32_bf16 v[84:87], v[124:127], v[100:103], v[84:87]
    s_cbranch_vccnz P5_SK6
    v_mfma_f32_16x16x32_bf16 v[56:59], v[116:119], v[104:107], v[56:59]
    v_mfma_f32_16x16x32_bf16 v[60:63], v[116:119], v[108:111], v[60:63]
    v_mfma_f32_16x16x32_bf16 v[88:91], v[124:127], v[104:107], v[88:91]
    v_mfma_f32_16x16x32_bf16 v[92:95], v[124:127], v[108:111], v[92:95]
P5_SK6:
    s_waitcnt lgkmcnt(0)
    s_barrier
    v_mfma_f32_16x16x32_bf16 v[32:35], v[144:147], v[128:131], v[32:35]
    ds_read_b128 v[96:99], v7 offset:16384
    v_mfma_f32_16x16x32_bf16 v[36:39], v[144:147], v[132:135], v[36:39]
    ds_read_b128 v[112:115], v24 offset:0
    v_mfma_f32_16x16x32_bf16 v[64:67], v[152:155], v[128:131], v[64:67]
    ds_read_b128 v[100:103], v7 offset:16640
    v_mfma_f32_16x16x32_bf16 v[68:71], v[152:155], v[132:135], v[68:71]
    ds_read_b128 v[120:123], v24 offset:14336
    v_mfma_f32_16x16x32_bf16 v[40:43], v[144:147], v[136:139], v[40:43]
    v_mfma_f32_16x16x32_bf16 v[72:75], v[152:155], v[136:139], v[72:75]
    ds_read_b128 v[104:107], v6 offset:16384
    v_mfma_f32_16x16x32_bf16 v[44:47], v[144:147], v[140:143], v[44:47]
    ds_read_b128 v[108:111], v6 offset:16640
    v_mfma_f32_16x16x32_bf16 v[76:79], v[152:155], v[140:143], v[76:79]
    ds_read_b128 v[116:119], v25 offset:0
    v_mfma_f32_16x16x32_bf16 v[48:51], v[148:151], v[128:131], v[48:51]
    ds_read_b128 v[124:127], v25 offset:14336
    v_mfma_f32_16x16x32_bf16 v[52:55], v[148:151], v[132:135], v[52:55]
    v_mfma_f32_16x16x32_bf16 v[80:83], v[156:159], v[128:131], v[80:83]
    v_mfma_f32_16x16x32_bf16 v[84:87], v[156:159], v[132:135], v[84:87]
    s_cbranch_vccnz P5_SK7
    v_mfma_f32_16x16x32_bf16 v[56:59], v[148:151], v[136:139], v[56:59]
    v_mfma_f32_16x16x32_bf16 v[60:63], v[148:151], v[140:143], v[60:63]
    v_mfma_f32_16x16x32_bf16 v[88:91], v[156:159], v[136:139], v[88:91]
    v_mfma_f32_16x16x32_bf16 v[92:95], v[156:159], v[140:143], v[92:95]
P5_SK7:
    s_waitcnt lgkmcnt(6)
    v_mfma_f32_16x16x32_bf16 v[32:35], v[112:115], v[96:99], v[32:35]
    ds_read_b128 v[128:131], v7 offset:18432
    s_waitcnt lgkmcnt(6)
    v_mfma_f32_16x16x32_bf16 v[36:39], v[112:115], v[100:103], v[36:39]
    ds_read_b128 v[144:147], v24 offset:1024
    s_waitcnt lgkmcnt(6)
    v_mfma_f32_16x16x32_bf16 v[64:67], v[120:123], v[96:99], v[64:67]
    ds_read_b128 v[132:135], v7 offset:18688
    v_mfma_f32_16x16x32_bf16 v[68:71], v[120:123], v[100:103], v[68:71]
    ds_read_b128 v[152:155], v24 offset:15360
    s_waitcnt lgkmcnt(7)
    v_mfma_f32_16x16x32_bf16 v[40:43], v[112:115], v[104:107], v[40:43]
    v_mfma_f32_16x16x32_bf16 v[72:75], v[120:123], v[104:107], v[72:75]
    ds_read_b128 v[136:139], v6 offset:18432
    s_waitcnt lgkmcnt(7)
    v_mfma_f32_16x16x32_bf16 v[44:47], v[112:115], v[108:111], v[44:47]
    ds_read_b128 v[140:143], v6 offset:18688
    v_mfma_f32_16x16x32_bf16 v[76:79], v[120:123], v[108:111], v[76:79]
    ds_read_b128 v[148:151], v25 offset:1024
    s_waitcnt lgkmcnt(8)
    v_mfma_f32_16x16x32_bf16 v[48:51], v[116:119], v[96:99], v[48:51]
    ds_read_b128 v[156:159], v25 offset:15360
    v_mfma_f32_16x16x32_bf16 v[52:55], v[116:119], v[100:103], v[52:55]
    s_waitcnt lgkmcnt(8)
    v_mfma_f32_16x16x32_bf16 v[80:83], v[124:127], v[96:99], v[80:83]
    v_mfma_f32_16x16x32_bf16 v[84:87], v[124:127], v[100:103], v[84:87]
    s_cbranch_vccnz P5_SK8
    v_mfma_f32_16x16x32_bf16 v[56:59], v[116:119], v[104:107], v[56:59]
    v_mfma_f32_16x16x32_bf16 v[60:63], v[116:119], v[108:111], v[60:63]
    v_mfma_f32_16x16x32_bf16 v[88:91], v[124:127], v[104:107], v[88:91]
    v_mfma_f32_16x16x32_bf16 v[92:95], v[124:127], v[108:111], v[92:95]
P5_SK8:
    s_waitcnt lgkmcnt(0)
    s_barrier
    v_mfma_f32_16x16x32_bf16 v[32:35], v[144:147], v[128:131], v[32:35]
    ds_read_b128 v[96:99], v17 offset:0
    v_mfma_f32_16x16x32_bf16 v[36:39], v[144:147], v[132:135], v[36:39]
    ds_read_b128 v[112:115], v20 offset:0
    v_mfma_f32_16x16x32_bf16 v[64:67], v[152:155], v[128:131], v[64:67]
    ds_read_b128 v[100:103], v17 offset:256
    v_mfma_f32_16x16x32_bf16 v[68:71], v[152:155], v[132:135], v[68:71]
    ds_read_b128 v[120:123], v20 offset:14336
    v_mfma_f32_16x16x32_bf16 v[40:43], v[144:147], v[136:139], v[40:43]
    v_mfma_f32_16x16x32_bf16 v[72:75], v[152:155], v[136:139], v[72:75]
    ds_read_b128 v[104:107], v16 offset:0
    v_mfma_f32_16x16x32_bf16 v[44:47], v[144:147], v[140:143], v[44:47]
    ds_read_b128 v[108:111], v16 offset:256
    v_mfma_f32_16x16x32_bf16 v[76:79], v[152:155], v[140:143], v[76:79]
    ds_read_b128 v[116:119], v23 offset:0
    v_mfma_f32_16x16x32_bf16 v[48:51], v[148:151], v[128:131], v[48:51]
    ds_read_b128 v[124:127], v23 offset:14336
    v_mfma_f32_16x16x32_bf16 v[52:55], v[148:151], v[132:135], v[52:55]
    v_mfma_f32_16x16x32_bf16 v[80:83], v[156:159], v[128:131], v[80:83]
    v_mfma_f32_16x16x32_bf16 v[84:87], v[156:159], v[132:135], v[84:87]
    s_cbranch_vccnz P5_SK9
    v_mfma_f32_16x16x32_bf16 v[56:59], v[148:151], v[136:139], v[56:59]
    v_mfma_f32_16x16x32_bf16 v[60:63], v[148:151], v[140:143], v[60:63]
    v_mfma_f32_16x16x32_bf16 v[88:91], v[156:159], v[136:139], v[88:91]
    v_mfma_f32_16x16x32_bf16 v[92:95], v[156:159], v[140:143], v[92:95]
P5_SK9:
    s_waitcnt lgkmcnt(6)
    v_mfma_f32_16x16x32_bf16 v[32:35], v[112:115], v[96:99], v[32:35]
    ds_read_b128 v[128:131], v17 offset:2048
    s_waitcnt lgkmcnt(6)
    v_mfma_f32_16x16x32_bf16 v[36:39], v[112:115], v[100:103], v[36:39]
    ds_read_b128 v[144:147], v20 offset:1024
    s_waitcnt lgkmcnt(6)
    v_mfma_f32_16x16x32_bf16 v[64:67], v[120:123], v[96:99], v[64:67]
    ds_read_b128 v[132:135], v17 offset:2304
    v_mfma_f32_16x16x32_bf16 v[68:71], v[120:123], v[100:103], v[68:71]
    ds_read_b128 v[152:155], v20 offset:15360
    s_waitcnt lgkmcnt(7)
    v_mfma_f32_16x16x32_bf16 v[40:43], v[112:115], v[104:107], v[40:43]
    v_mfma_f32_16x16x32_bf16 v[72:75], v[120:123], v[104:107], v[72:75]
    ds_read_b128 v[136:139], v16 offset:2048
    s_waitcnt lgkmcnt(7)
    v_mfma_f32_16x16x32_bf16 v[44:47], v[112:115], v[108:111], v[44:47]
    ds_read_b128 v[140:143], v16 offset:2304
    v_mfma_f32_16x16x32_bf16 v[76:79], v[120:123], v[108:111], v[76:79]
    ds_read_b128 v[148:151], v23 offset:1024
    s_waitcnt lgkmcnt(8)
    v_mfma_f32_16x16x32_bf16 v[48:51], v[116:119], v[96:99], v[48:51]
    ds_read_b128 v[156:159], v23 offset:15360
    v_mfma_f32_16x16x32_bf16 v[52:55], v[116:119], v[100:103], v[52:55]
    s_waitcnt lgkmcnt(8)
    v_mfma_f32_16x16x32_bf16 v[80:83], v[124:127], v[96:99], v[80:83]
    v_mfma_f32_16x16x32_bf16 v[84:87], v[124:127], v[100:103], v[84:87]
    s_cbranch_vccnz P5_SK10
    v_mfma_f32_16x16x32_bf16 v[56:59], v[116:119], v[104:107], v[56:59]
    v_mfma_f32_16x16x32_bf16 v[60:63], v[116:119], v[108:111], v[60:63]
    v_mfma_f32_16x16x32_bf16 v[88:91], v[124:127], v[104:107], v[88:91]
    v_mfma_f32_16x16x32_bf16 v[92:95], v[124:127], v[108:111], v[92:95]
P5_SK10:
    s_waitcnt lgkmcnt(0)
    s_barrier
    v_mfma_f32_16x16x32_bf16 v[32:35], v[144:147], v[128:131], v[32:35]
    ds_read_b128 v[96:99], v7 offset:0
    v_mfma_f32_16x16x32_bf16 v[36:39], v[144:147], v[132:135], v[36:39]
    ds_read_b128 v[112:115], v18 offset:0
    v_mfma_f32_16x16x32_bf16 v[64:67], v[152:155], v[128:131], v[64:67]
    ds_read_b128 v[100:103], v7 offset:256
    v_mfma_f32_16x16x32_bf16 v[68:71], v[152:155], v[132:135], v[68:71]
    ds_read_b128 v[120:123], v18 offset:14336
    v_mfma_f32_16x16x32_bf16 v[40:43], v[144:147], v[136:139], v[40:43]
    v_mfma_f32_16x16x32_bf16 v[72:75], v[152:155], v[136:139], v[72:75]
    ds_read_b128 v[104:107], v6 offset:0
    v_mfma_f32_16x16x32_bf16 v[44:47], v[144:147], v[140:143], v[44:47]
    ds_read_b128 v[108:111], v6 offset:256
    v_mfma_f32_16x16x32_bf16 v[76:79], v[152:155], v[140:143], v[76:79]
    ds_read_b128 v[116:119], v21 offset:0
    v_mfma_f32_16x16x32_bf16 v[48:51], v[148:151], v[128:131], v[48:51]
    ds_read_b128 v[124:127], v21 offset:14336
    v_mfma_f32_16x16x32_bf16 v[52:55], v[148:151], v[132:135], v[52:55]
    v_mfma_f32_16x16x32_bf16 v[80:83], v[156:159], v[128:131], v[80:83]
    v_mfma_f32_16x16x32_bf16 v[84:87], v[156:159], v[132:135], v[84:87]
    s_cbranch_vccnz P5_SK11
    v_mfma_f32_16x16x32_bf16 v[56:59], v[148:151], v[136:139], v[56:59]
    v_mfma_f32_16x16x32_bf16 v[60:63], v[148:151], v[140:143], v[60:63]
    v_mfma_f32_16x16x32_bf16 v[88:91], v[156:159], v[136:139], v[88:91]
    v_mfma_f32_16x16x32_bf16 v[92:95], v[156:159], v[140:143], v[92:95]
P5_SK11:
    s_waitcnt lgkmcnt(6)
    v_mfma_f32_16x16x32_bf16 v[32:35], v[112:115], v[96:99], v[32:35]
    ds_read_b128 v[128:131], v7 offset:2048
    s_waitcnt lgkmcnt(6)
    v_mfma_f32_16x16x32_bf16 v[36:39], v[112:115], v[100:103], v[36:39]
    ds_read_b128 v[144:147], v18 offset:1024
    s_waitcnt lgkmcnt(6)
    v_mfma_f32_16x16x32_bf16 v[64:67], v[120:123], v[96:99], v[64:67]
    ds_read_b128 v[132:135], v7 offset:2304
    v_mfma_f32_16x16x32_bf16 v[68:71], v[120:123], v[100:103], v[68:71]
    ds_read_b128 v[152:155], v18 offset:15360
    s_waitcnt lgkmcnt(7)
    v_mfma_f32_16x16x32_bf16 v[40:43], v[112:115], v[104:107], v[40:43]
    v_mfma_f32_16x16x32_bf16 v[72:75], v[120:123], v[104:107], v[72:75]
    ds_read_b128 v[136:139], v6 offset:2048
    s_waitcnt lgkmcnt(7)
    v_mfma_f32_16x16x32_bf16 v[44:47], v[112:115], v[108:111], v[44:47]
    ds_read_b128 v[140:143], v6 offset:2304
    v_mfma_f32_16x16x32_bf16 v[76:79], v[120:123], v[108:111], v[76:79]
    ds_read_b128 v[148:151], v21 offset:1024
    s_waitcnt lgkmcnt(8)
    v_mfma_f32_16x16x32_bf16 v[48:51], v[116:119], v[96:99], v[48:51]
    ds_read_b128 v[156:159], v21 offset:15360
    v_mfma_f32_16x16x32_bf16 v[52:55], v[116:119], v[100:103], v[52:55]
    s_waitcnt lgkmcnt(8)
    v_mfma_f32_16x16x32_bf16 v[80:83], v[124:127], v[96:99], v[80:83]
    v_mfma_f32_16x16x32_bf16 v[84:87], v[124:127], v[100:103], v[84:87]
    s_cbranch_vccnz P5_SK12
    v_mfma_f32_16x16x32_bf16 v[56:59], v[116:119], v[104:107], v[56:59]
    v_mfma_f32_16x16x32_bf16 v[60:63], v[116:119], v[108:111], v[60:63]
    v_mfma_f32_16x16x32_bf16 v[88:91], v[124:127], v[104:107], v[88:91]
    v_mfma_f32_16x16x32_bf16 v[92:95], v[124:127], v[108:111], v[92:95]
P5_SK12:
    s_waitcnt lgkmcnt(0)
    s_barrier
    v_mfma_f32_16x16x32_bf16 v[32:35], v[144:147], v[128:131], v[32:35]
    ds_read_b128 v[96:99], v7 offset:16384
    v_mfma_f32_16x16x32_bf16 v[36:39], v[144:147], v[132:135], v[36:39]
    ds_read_b128 v[112:115], v24 offset:0
    v_mfma_f32_16x16x32_bf16 v[64:67], v[152:155], v[128:131], v[64:67]
    ds_read_b128 v[100:103], v7 offset:16640
    v_mfma_f32_16x16x32_bf16 v[68:71], v[152:155], v[132:135], v[68:71]
    ds_read_b128 v[120:123], v24 offset:14336
    v_mfma_f32_16x16x32_bf16 v[40:43], v[144:147], v[136:139], v[40:43]
    v_mfma_f32_16x16x32_bf16 v[72:75], v[152:155], v[136:139], v[72:75]
    ds_read_b128 v[104:107], v6 offset:16384
    v_mfma_f32_16x16x32_bf16 v[44:47], v[144:147], v[140:143], v[44:47]
    ds_read_b128 v[108:111], v6 offset:16640
    v_mfma_f32_16x16x32_bf16 v[76:79], v[152:155], v[140:143], v[76:79]
    ds_read_b128 v[116:119], v25 offset:0
    v_mfma_f32_16x16x32_bf16 v[48:51], v[148:151], v[128:131], v[48:51]
    ds_read_b128 v[124:127], v25 offset:14336
    v_mfma_f32_16x16x32_bf16 v[52:55], v[148:151], v[132:135], v[52:55]
    v_mfma_f32_16x16x32_bf16 v[80:83], v[156:159], v[128:131], v[80:83]
    v_mfma_f32_16x16x32_bf16 v[84:87], v[156:159], v[132:135], v[84:87]
    s_cbranch_vccnz P5_SK13
    v_mfma_f32_16x16x32_bf16 v[56:59], v[148:151], v[136:139], v[56:59]
    v_mfma_f32_16x16x32_bf16 v[60:63], v[148:151], v[140:143], v[60:63]
    v_mfma_f32_16x16x32_bf16 v[88:91], v[156:159], v[136:139], v[88:91]
    v_mfma_f32_16x16x32_bf16 v[92:95], v[156:159], v[140:143], v[92:95]
P5_SK13:
    s_waitcnt lgkmcnt(0)
    v_mfma_f32_16x16x32_bf16 v[32:35], v[112:115], v[96:99], v[32:35]
    ds_read_b128 v[128:131], v7 offset:18432
    ds_read_b128 v[144:147], v24 offset:1024
    v_mfma_f32_16x16x32_bf16 v[36:39], v[112:115], v[100:103], v[36:39]
    ds_read_b128 v[132:135], v7 offset:18688
    ds_read_b128 v[152:155], v24 offset:15360
    v_mfma_f32_16x16x32_bf16 v[64:67], v[120:123], v[96:99], v[64:67]
    ds_read_b128 v[136:139], v6 offset:18432
    ds_read_b128 v[140:143], v6 offset:18688
    v_mfma_f32_16x16x32_bf16 v[68:71], v[120:123], v[100:103], v[68:71]
    ds_read_b128 v[148:151], v25 offset:1024
    ds_read_b128 v[156:159], v25 offset:15360
    v_mfma_f32_16x16x32_bf16 v[48:51], v[116:119], v[96:99], v[48:51]
    v_mfma_f32_16x16x32_bf16 v[52:55], v[116:119], v[100:103], v[52:55]
    ds_read_b128 v[8:11], v19 offset:0
    ds_read_b128 v[12:15], v19 offset:256
    ds_read_b128 v[16:19], v22 offset:0
    ds_read_b128 v[20:23], v22 offset:256
    v_mfma_f32_16x16x32_bf16 v[80:83], v[124:127], v[96:99], v[80:83]
    v_mfma_f32_16x16x32_bf16 v[84:87], v[124:127], v[100:103], v[84:87]
    s_waitcnt lgkmcnt(10)
    s_mov_b64 exec, 0xffff
    ds_read_b64 v[26:27], v4 offset:0
    ds_read_b64 v[28:29], v0 offset:0
    ds_read_b64 v[30:31], v4 offset:1024
    ds_read_b64 v[2:3], v0 offset:1024
    s_mov_b64 exec, -1
    s_waitcnt lgkmcnt(8)
    v_mfma_f32_16x16x32_bf16 v[32:35], v[144:147], v[128:131], v[32:35]
    v_mfma_f32_16x16x32_bf16 v[36:39], v[144:147], v[132:135], v[36:39]
    v_mfma_f32_16x16x32_bf16 v[64:67], v[152:155], v[128:131], v[64:67]
    v_mfma_f32_16x16x32_bf16 v[68:71], v[152:155], v[132:135], v[68:71]
    s_waitcnt lgkmcnt(0)
    v_mfma_f32_16x16x16_bf16 v[32:35], v[26:27], v[8:9], v[32:35]
    v_mfma_f32_16x16x16_bf16 v[36:39], v[26:27], v[12:13], v[36:39]
    v_mfma_f32_16x16x16_bf16 v[64:67], v[30:31], v[8:9], v[64:67]
    v_mfma_f32_16x16x16_bf16 v[68:71], v[30:31], v[12:13], v[68:71]
    v_mfma_f32_16x16x32_bf16 v[48:51], v[148:151], v[128:131], v[48:51]
    v_mfma_f32_16x16x32_bf16 v[52:55], v[148:151], v[132:135], v[52:55]
    v_mfma_f32_16x16x32_bf16 v[80:83], v[156:159], v[128:131], v[80:83]
    s_nop 1
    v_mul_f32 v32, v10, v32
    v_mul_f32 v33, v10, v33
    v_mul_f32 v34, v10, v34
    v_mul_f32 v35, v10, v35
    v_mul_f32 v36, v14, v36
    v_mul_f32 v37, v14, v37
    v_mfma_f32_16x16x32_bf16 v[84:87], v[156:159], v[132:135], v[84:87]
    v_mul_f32 v38, v14, v38
    v_mul_f32 v39, v14, v39
    v_exp_f32 v96, v32
    v_mul_f32 v64, v64, v32
    v_exp_f32 v97, v33
    v_mul_f32 v65, v65, v33
    v_exp_f32 v98, v34
    v_mfma_f32_16x16x16_bf16 v[48:51], v[28:29], v[8:9], v[48:51]
    v_mul_f32 v66, v66, v34
    v_exp_f32 v99, v35
    v_mul_f32 v67, v67, v35
    v_exp_f32 v100, v36
    v_mul_f32 v68, v68, v36
    v_exp_f32 v101, v37
    v_mul_f32 v69, v69, v37
    v_mfma_f32_16x16x16_bf16 v[52:55], v[28:29], v[12:13], v[52:55]
    v_exp_f32 v102, v38
    v_mul_f32 v70, v70, v38
    v_exp_f32 v103, v39
    v_mul_f32 v71, v71, v39
    v_fma_f32 v96, v96, v11, v11
    v_fma_f32 v97, v97, v11, v11
    v_fma_f32 v98, v98, v11, v11
    v_mfma_f32_16x16x16_bf16 v[80:83], v[2:3], v[8:9], v[80:83]
    v_fma_f32 v99, v99, v11, v11
    v_fma_f32 v100, v100, v15, v15
    v_fma_f32 v101, v101, v15, v15
    v_fma_f32 v102, v102, v15, v15
    v_fma_f32 v103, v103, v15, v15
    v_rcp_f32 v96, v96
    v_rcp_f32 v97, v97
    v_mfma_f32_16x16x16_bf16 v[84:87], v[2:3], v[12:13], v[84:87]
    v_rcp_f32 v98, v98
    v_rcp_f32 v99, v99
    v_rcp_f32 v100, v100
    v_rcp_f32 v101, v101
    v_rcp_f32 v102, v102
    v_rcp_f32 v103, v103
    v_mul_f32 v64, v64, v96
    v_mfma_f32_16x16x32_bf16 v[40:43], v[112:115], v[104:107], v[40:43]
    v_mul_f32 v65, v65, v97
    v_mul_f32 v66, v66, v98
    v_mul_f32 v67, v67, v99
    v_mul_f32 v68, v68, v100
    v_mul_f32 v69, v69, v101
    v_mul_f32 v70, v70, v102
    v_mul_f32 v71, v71, v103
    v_mfma_f32_16x16x32_bf16 v[44:47], v[112:115], v[108:111], v[44:47]
    v_cvt_pk_bf16_f32 v32, v64, v65
    v_cvt_pk_bf16_f32 v34, v68, v69
    v_cvt_pk_bf16_f32 v33, v66, v67
    v_cvt_pk_bf16_f32 v35, v70, v71
    v_permlane16_swap_b32 v32, v34
    s_nop 0
    v_permlane16_swap_b32 v33, v35
    buffer_store_dwordx4 v[32:35], v5, s[52:55], s4 offen sc1
    v_mfma_f32_16x16x32_bf16 v[72:75], v[120:123], v[104:107], v[72:75]
    v_mul_f32 v48, v10, v48
    v_mul_f32 v49, v10, v49
    v_mul_f32 v50, v10, v50
    v_mul_f32 v51, v10, v51
    v_mul_f32 v52, v14, v52
    v_mfma_f32_16x16x32_bf16 v[76:79], v[120:123], v[108:111], v[76:79]
    v_mul_f32 v53, v14, v53
    v_mul_f32 v54, v14, v54
    v_mul_f32 v55, v14, v55
    v_exp_f32 v128, v48
    v_mul_f32 v80, v80, v48
    v_exp_f32 v129, v49
    v_mfma_f32_16x16x32_bf16 v[40:43], v[144:147], v[136:139], v[40:43]
    v_mul_f32 v81, v81, v49
    v_exp_f32 v130, v50
    v_mul_f32 v82, v82, v50
    v_exp_f32 v131, v51
    v_mul_f32 v83, v83, v51
    v_mfma_f32_16x16x32_bf16 v[44:47], v[144:147], v[140:143], v[44:47]
    v_exp_f32 v132, v52
    v_mul_f32 v84, v84, v52
    v_exp_f32 v133, v53
    v_mul_f32 v85, v85, v53
    v_exp_f32 v134, v54
    v_mul_f32 v86, v86, v54
    v_mfma_f32_16x16x32_bf16 v[72:75], v[152:155], v[136:139], v[72:75]
    v_exp_f32 v135, v55
    v_mul_f32 v87, v87, v55
    v_fma_f32 v128, v128, v11, v11
    v_fma_f32 v129, v129, v11, v11
    v_fma_f32 v130, v130, v11, v11
    v_mfma_f32_16x16x32_bf16 v[76:79], v[152:155], v[140:143], v[76:79]
    v_fma_f32 v131, v131, v11, v11
    v_fma_f32 v132, v132, v15, v15
    v_fma_f32 v133, v133, v15, v15
    v_fma_f32 v134, v134, v15, v15
    v_fma_f32 v135, v135, v15, v15
    v_rcp_f32 v128, v128
    v_mfma_f32_16x16x16_bf16 v[40:43], v[26:27], v[16:17], v[40:43]
    v_rcp_f32 v129, v129
    v_rcp_f32 v130, v130
    v_rcp_f32 v131, v131
    v_rcp_f32 v132, v132
    v_rcp_f32 v133, v133
    v_mfma_f32_16x16x16_bf16 v[44:47], v[26:27], v[20:21], v[44:47]
    v_rcp_f32 v134, v134
    v_rcp_f32 v135, v135
    v_mul_f32 v80, v80, v128
    v_mul_f32 v81, v81, v129
    v_mul_f32 v82, v82, v130
    v_mul_f32 v83, v83, v131
    v_mfma_f32_16x16x16_bf16 v[72:75], v[30:31], v[16:17], v[72:75]
    v_mul_f32 v84, v84, v132
    v_mul_f32 v85, v85, v133
    v_mul_f32 v86, v86, v134
    v_mul_f32 v87, v87, v135
    v_cvt_pk_bf16_f32 v48, v80, v81
    v_mfma_f32_16x16x16_bf16 v[76:79], v[30:31], v[20:21], v[76:79]
    v_cvt_pk_bf16_f32 v50, v84, v85
    v_cvt_pk_bf16_f32 v49, v82, v83
    v_cvt_pk_bf16_f32 v51, v86, v87
    v_permlane16_swap_b32 v48, v50
    s_nop 0
    v_permlane16_swap_b32 v49, v51
    buffer_store_dwordx4 v[48:51], v5, s[52:55], s5 offen sc1
    s_cbranch_vccnz P5_YT
    v_mfma_f32_16x16x32_bf16 v[56:59], v[116:119], v[104:107], v[56:59]
    v_mfma_f32_16x16x32_bf16 v[60:63], v[116:119], v[108:111], v[60:63]
    v_mfma_f32_16x16x32_bf16 v[88:91], v[124:127], v[104:107], v[88:91]
    v_mul_f32 v40, v18, v40
    v_mul_f32 v41, v18, v41
    v_mul_f32 v42, v18, v42
    v_mul_f32 v43, v18, v43
    v_mul_f32 v44, v22, v44
    v_mfma_f32_16x16x32_bf16 v[92:95], v[124:127], v[108:111], v[92:95]
    v_mul_f32 v45, v22, v45
    v_mul_f32 v46, v22, v46
    v_mul_f32 v47, v22, v47
    v_exp_f32 v96, v40
    v_mul_f32 v72, v72, v40
    v_exp_f32 v97, v41
    v_mfma_f32_16x16x32_bf16 v[56:59], v[148:151], v[136:139], v[56:59]
    v_mul_f32 v73, v73, v41
    v_exp_f32 v98, v42
    v_mul_f32 v74, v74, v42
    v_exp_f32 v99, v43
    v_mul_f32 v75, v75, v43
    v_mfma_f32_16x16x32_bf16 v[60:63], v[148:151], v[140:143], v[60:63]
    v_exp_f32 v100, v44
    v_mul_f32 v76, v76, v44
    v_exp_f32 v101, v45
    v_mul_f32 v77, v77, v45
    v_exp_f32 v102, v46
    v_mul_f32 v78, v78, v46
    v_mfma_f32_16x16x32_bf16 v[88:91], v[156:159], v[136:139], v[88:91]
    v_exp_f32 v103, v47
    v_mul_f32 v79, v79, v47
    v_fma_f32 v96, v96, v19, v19
    v_fma_f32 v97, v97, v19, v19
    v_fma_f32 v98, v98, v19, v19
    v_mfma_f32_16x16x32_bf16 v[92:95], v[156:159], v[140:143], v[92:95]
    v_fma_f32 v99, v99, v19, v19
    v_fma_f32 v100, v100, v23, v23
    v_fma_f32 v101, v101, v23, v23
    v_fma_f32 v102, v102, v23, v23
    v_fma_f32 v103, v103, v23, v23
    v_rcp_f32 v96, v96
    v_mfma_f32_16x16x16_bf16 v[56:59], v[28:29], v[16:17], v[56:59]
    v_rcp_f32 v97, v97
    v_rcp_f32 v98, v98
    v_rcp_f32 v99, v99
    v_rcp_f32 v100, v100
    v_rcp_f32 v101, v101
    v_mfma_f32_16x16x16_bf16 v[60:63], v[28:29], v[20:21], v[60:63]
    v_rcp_f32 v102, v102
    v_rcp_f32 v103, v103
    v_mul_f32 v72, v72, v96
    v_mul_f32 v73, v73, v97
    v_mul_f32 v74, v74, v98
    v_mul_f32 v75, v75, v99
    v_mfma_f32_16x16x16_bf16 v[88:91], v[2:3], v[16:17], v[88:91]
    v_mul_f32 v76, v76, v100
    v_mul_f32 v77, v77, v101
    v_mul_f32 v78, v78, v102
    v_mul_f32 v79, v79, v103
    v_cvt_pk_bf16_f32 v40, v72, v73
    v_mfma_f32_16x16x16_bf16 v[92:95], v[2:3], v[20:21], v[92:95]
    v_cvt_pk_bf16_f32 v42, v76, v77
    v_cvt_pk_bf16_f32 v41, v74, v75
    v_cvt_pk_bf16_f32 v43, v78, v79
    v_permlane16_swap_b32 v40, v42
    s_nop 0
    v_permlane16_swap_b32 v41, v43
    buffer_store_dwordx4 v[40:43], v5, s[52:55], s6 offen sc1
    v_pk_mul_f32 v[56:57], v[56:57], v[18:19] op_sel_hi:[1,0]
    v_pk_mul_f32 v[58:59], v[58:59], v[18:19] op_sel_hi:[1,0]
    v_pk_mul_f32 v[60:61], v[60:61], v[22:23] op_sel_hi:[1,0]
    v_pk_mul_f32 v[62:63], v[62:63], v[22:23] op_sel_hi:[1,0]
    v_exp_f32 v136, v56
    v_exp_f32 v137, v57
    v_exp_f32 v138, v58
    v_exp_f32 v139, v59
    v_exp_f32 v140, v60
    v_exp_f32 v141, v61
    v_exp_f32 v142, v62
    v_exp_f32 v143, v63
    v_pk_mul_f32 v[88:89], v[88:89], v[56:57]
    v_pk_mul_f32 v[90:91], v[90:91], v[58:59]
    v_pk_mul_f32 v[92:93], v[92:93], v[60:61]
    v_pk_mul_f32 v[94:95], v[94:95], v[62:63]
    v_pk_fma_f32 v[136:137], v[136:137], v[18:19], v[18:19] op_sel:[0,1,1] op_sel_hi:[1,1,1]
    v_pk_fma_f32 v[138:139], v[138:139], v[18:19], v[18:19] op_sel:[0,1,1] op_sel_hi:[1,1,1]
    v_pk_fma_f32 v[140:141], v[140:141], v[22:23], v[22:23] op_sel:[0,1,1] op_sel_hi:[1,1,1]
    v_pk_fma_f32 v[142:143], v[142:143], v[22:23], v[22:23] op_sel:[0,1,1] op_sel_hi:[1,1,1]
    v_rcp_f32 v136, v136
    v_rcp_f32 v137, v137
    v_rcp_f32 v138, v138
    v_rcp_f32 v139, v139
    v_rcp_f32 v140, v140
    v_rcp_f32 v141, v141
    v_rcp_f32 v142, v142
    v_rcp_f32 v143, v143
    v_pk_mul_f32 v[88:89], v[88:89], v[136:137]
    v_pk_mul_f32 v[90:91], v[90:91], v[138:139]
    v_pk_mul_f32 v[92:93], v[92:93], v[140:141]
    v_pk_mul_f32 v[94:95], v[94:95], v[142:143]
    v_cvt_pk_bf16_f32 v56, v88, v89
    v_cvt_pk_bf16_f32 v58, v92, v93
    v_cvt_pk_bf16_f32 v57, v90, v91
    v_cvt_pk_bf16_f32 v59, v94, v95
    v_permlane16_swap_b32 v56, v58
    s_nop 0
    v_permlane16_swap_b32 v57, v59
    buffer_store_dwordx4 v[56:59], v5, s[52:55], s7 offen sc1
    s_branch P5_JN
P5_YT:
    s_nop 4
    v_pk_mul_f32 v[40:41], v[40:41], v[18:19] op_sel_hi:[1,0]
    v_pk_mul_f32 v[42:43], v[42:43], v[18:19] op_sel_hi:[1,0]
    v_pk_mul_f32 v[44:45], v[44:45], v[22:23] op_sel_hi:[1,0]
    v_pk_mul_f32 v[46:47], v[46:47], v[22:23] op_sel_hi:[1,0]
    v_exp_f32 v104, v40
    v_exp_f32 v105, v41
    v_exp_f32 v106, v42
    v_exp_f32 v107, v43
    v_exp_f32 v108, v44
    v_exp_f32 v109, v45
    v_exp_f32 v110, v46
    v_exp_f32 v111, v47
    v_pk_mul_f32 v[72:73], v[72:73], v[40:41]
    v_pk_mul_f32 v[74:75], v[74:75], v[42:43]
    v_pk_mul_f32 v[76:77], v[76:77], v[44:45]
    v_pk_mul_f32 v[78:79], v[78:79], v[46:47]
    v_pk_fma_f32 v[104:105], v[104:105], v[18:19], v[18:19] op_sel:[0,1,1] op_sel_hi:[1,1,1]
    v_pk_fma_f32 v[106:107], v[106:107], v[18:19], v[18:19] op_sel:[0,1,1] op_sel_hi:[1,1,1]
    v_pk_fma_f32 v[108:109], v[108:109], v[22:23], v[22:23] op_sel:[0,1,1] op_sel_hi:[1,1,1]
    v_pk_fma_f32 v[110:111], v[110:111], v[22:23], v[22:23] op_sel:[0,1,1] op_sel_hi:[1,1,1]
    v_rcp_f32 v104, v104
    v_rcp_f32 v105, v105
    v_rcp_f32 v106, v106
    v_rcp_f32 v107, v107
    v_rcp_f32 v108, v108
    v_rcp_f32 v109, v109
    v_rcp_f32 v110, v110
    v_rcp_f32 v111, v111
    v_pk_mul_f32 v[72:73], v[72:73], v[104:105]
    v_pk_mul_f32 v[74:75], v[74:75], v[106:107]
    v_pk_mul_f32 v[76:77], v[76:77], v[108:109]
    v_pk_mul_f32 v[78:79], v[78:79], v[110:111]
    v_cvt_pk_bf16_f32 v40, v72, v73
    v_cvt_pk_bf16_f32 v42, v76, v77
    v_cvt_pk_bf16_f32 v41, v74, v75
    v_cvt_pk_bf16_f32 v43, v78, v79
    v_permlane16_swap_b32 v40, v42
    s_nop 0
    v_permlane16_swap_b32 v41, v43
    buffer_store_dwordx4 v[40:43], v5, s[52:55], s6 offen sc1
P5_JN:
    s_cmp_lt_u32 s60, 4
    s_cbranch_scc1 P5_NCP
    v_and_b32 v4, 48, v1
    v_add_u32 v4, v4, v1
    v_lshlrev_b32 v4, 4, v4
    s_bfe_u32 s4, s2, 0x30003
    s_and_b32 s6, s60, 1
    s_lshl1_add_u32 s4, s4, s6
    s_lshr_b32 s6, s60, 1
    s_lshl2_add_u32 s4, s4, s6
    s_mul_i32 s4, s4, 28*1024
    s_add_u32 s4, s4, 20971520
    s_sub_u32 s5, s60, 4
    s_mul_i32 s6, s5, 12288
    s_add_u32 s6, s6, 65536
    v_add_u32 v8, s6, v4
    s_mul_i32 s6, s5, 10240
    s_add_u32 s6, s6, 118784
    v_add_u32 v9, s6, v4
    s_waitcnt vmcnt(0)
    s_barrier
    s_add_u32 s94, s4, 20480
    buffer_load_dwordx4 v[144:147], v4, s[52:55], s94 offen offset:2048 sc1
    buffer_load_dwordx4 v[148:151], v4, s[52:55], s94 offen offset:2304 sc1
    s_add_u32 s94, s4, 24576
    buffer_load_dwordx4 v[152:155], v4, s[52:55], s94 offen offset:0 sc1
    buffer_load_dwordx4 v[156:159], v4, s[52:55], s94 offen offset:256 sc1
    buffer_load_dwordx4 v[160:163], v4, s[52:55], s94 offen offset:2048 sc1
    buffer_load_dwordx4 v[164:167], v4, s[52:55], s94 offen offset:2304 sc1
    s_lshl_b32 s6, s5, 2
    s_add_u32 s6, s6, 49136
    v_mov_b32 v2, s6
    s_mov_b32 s95, 0x400000
LW_39:
    ds_read_b32 v3, v2 offset:0
    s_waitcnt lgkmcnt(0)
    v_cmp_eq_u32 vcc, 1, v3
    s_cbranch_vccnz LWE_40
    s_sub_u32 s95, s95, 1
    s_cmp_eq_u32 s95, 0
    s_cbranch_scc1 LWE_40
    s_sleep 1
    s_branch LW_39
LWE_40:
    ds_read_b128 v[56:59], v8 offset:0
    ds_read_b128 v[60:63], v8 offset:256
    ds_read_b128 v[64:67], v8 offset:2048
    ds_read_b128 v[68:71], v8 offset:2304
    ds_read_b128 v[72:75], v8 offset:4096
    ds_read_b128 v[76:79], v8 offset:4352
    ds_read_b128 v[80:83], v8 offset:6144
    ds_read_b128 v[84:87], v8 offset:6400
    ds_read_b128 v[88:91], v8 offset:8192
    ds_read_b128 v[92:95], v8 offset:8448
    ds_read_b128 v[96:99], v8 offset:10240
    ds_read_b128 v[100:103], v8 offset:10496
    s_waitcnt lgkmcnt(11)
    ds_read_b128 v[104:107], v9 offset:0
    s_waitcnt lgkmcnt(11)
    ds_read_b128 v[108:111], v9 offset:256
    s_waitcnt lgkmcnt(11)
    ds_read_b128 v[112:115], v9 offset:2048
    s_waitcnt lgkmcnt(11)
    ds_read_b128 v[116:119], v9 offset:2304
    s_waitcnt lgkmcnt(11)
    ds_read_b128 v[120:123], v9 offset:4096
    s_waitcnt lgkmcnt(11)
    ds_read_b128 v[124:127], v9 offset:4352
    s_waitcnt lgkmcnt(11)
    ds_read_b128 v[128:131], v9 offset:6144
    s_waitcnt lgkmcnt(11)
    ds_read_b128 v[132:135], v9 offset:6400
    s_waitcnt lgkmcnt(11)
    ds_read_b128 v[136:139], v9 offset:8192
    s_waitcnt lgkmcnt(11)
    ds_read_b128 v[140:143], v9 offset:8448
    s_branch P5_END
P5_NCP:
    s_branch P5_END
P5_LOADER:
    s_setprio 3
    s_cmp_ge_u32 s60, 10
    s_cbranch_scc1 P5_X
    s_cmp_eq_u32 s60, 8
    s_cbranch_scc0 P5_LB
    v_lshlrev_b32 v12, 4, v1
    s_lshl_b32 s6, s26, 7
    s_add_u32 s19, s6, 2048
    s_mov_b32 s11, 0
    s_lshl_b32 s18, 0x0707, s11
    s_bfe_u32 s18, s18, 0x80008
    s_lshl_b32 s12, 7, s11
    s_or_b32 s18, s18, s12
    s_and_b32 s18, s18, 0xff
    s_mul_i32 s18, s18, 0x101
    s_lshl_b32 s11, s11, 12
    s_lshl_b32 s12, s26, 17
    s_add_u32 s12, s12, 11534336
    s_add_u32 s4, s12, s11
    s_lshl_b32 s19, s19, 6
    s_add_u32 s19, s19, 524288
    v_min_u32 v14, 15, v1
    v_lshlrev_b32 v14, 8, v14
    s_mov_b32 s95, 0x20000
    s_waitcnt vmcnt(0)
    s_mov_b32 exec_lo, s18
    s_mov_b32 exec_hi, 0
    buffer_load_dwordx2 v[16:17], v14, s[52:55], s19 offen sc1
POLL_41:
    buffer_load_dwordx2 v[18:19], v14, s[52:55], s19 offen sc1
    s_waitcnt vmcnt(1)
    v_cmp_ne_u64 vcc, s[100:101], v[16:17]
    s_nop 0
    s_and_b64 exec, exec, vcc
    s_cbranch_scc0 POLLE_42
    buffer_load_dwordx2 v[16:17], v14, s[52:55], s19 offen sc1
    s_waitcnt vmcnt(1)
    v_cmp_ne_u64 vcc, s[100:101], v[18:19]
    s_nop 0
    s_and_b64 exec, exec, vcc
    s_cbranch_scc0 POLLE_42
    s_sub_u32 s95, s95, 1
    s_cmp_lg_u32 s95, 0
    s_cbranch_scc1 POLL_41
POLLE_42:
    s_mov_b64 exec, -1
    s_mov_b32 m0, 32768
    s_add_u32 s6, s4, 0
    buffer_load_dwordx4 v12, s[52:55], s6 offen offset:0 sc1 lds
    buffer_load_dwordx4 v12, s[52:55], s6 offen offset:1024 sc1 lds
    buffer_load_dwordx4 v12, s[52:55], s6 offen offset:2048 sc1 lds
    buffer_load_dwordx4 v12, s[52:55], s6 offen offset:3072 sc1 lds
    s_mov_b32 m0, 36864
    s_add_u32 s6, s4, 32768
    buffer_load_dwordx4 v12, s[52:55], s6 offen offset:0 sc1 lds
    buffer_load_dwordx4 v12, s[52:55], s6 offen offset:1024 sc1 lds
    buffer_load_dwordx4 v12, s[52:55], s6 offen offset:2048 sc1 lds
    buffer_load_dwordx4 v12, s[52:55], s6 offen offset:3072 sc1 lds
    s_mov_b32 m0, 40960
    s_add_u32 s6, s4, 65536
    buffer_load_dwordx4 v12, s[52:55], s6 offen offset:0 sc1 lds
    buffer_load_dwordx4 v12, s[52:55], s6 offen offset:1024 sc1 lds
    buffer_load_dwordx4 v12, s[52:55], s6 offen offset:2048 sc1 lds
    buffer_load_dwordx4 v12, s[52:55], s6 offen offset:3072 sc1 lds
    s_mov_b32 m0, 45056
    s_add_u32 s6, s4, 98304
    buffer_load_dwordx4 v12, s[52:55], s6 offen offset:0 sc1 lds
    buffer_load_dwordx4 v12, s[52:55], s6 offen offset:1024 sc1 lds
    buffer_load_dwordx4 v12, s[52:55], s6 offen offset:2048 sc1 lds
    buffer_load_dwordx4 v12, s[52:55], s6 offen offset:3072 sc1 lds
    s_add_u32 s11, s11, 4096
    s_and_b32 s11, s11, 0x7fff
    s_add_u32 s4, s12, s11
    s_mov_b32 m0, 49152
    s_add_u32 s6, s4, 0
    buffer_load_dwordx4 v12, s[52:55], s6 offen offset:0 sc1 lds
    buffer_load_dwordx4 v12, s[52:55], s6 offen offset:1024 sc1 lds
    buffer_load_dwordx4 v12, s[52:55], s6 offen offset:2048 sc1 lds
    buffer_load_dwordx4 v12, s[52:55], s6 offen offset:3072 sc1 lds
    s_mov_b32 m0, 53248
    s_add_u32 s6, s4, 32768
    buffer_load_dwordx4 v12, s[52:55], s6 offen offset:0 sc1 lds
    buffer_load_dwordx4 v12, s[52:55], s6 offen offset:1024 sc1 lds
    buffer_load_dwordx4 v12, s[52:55], s6 offen offset:2048 sc1 lds
    buffer_load_dwordx4 v12, s[52:55], s6 offen offset:3072 sc1 lds
    s_mov_b32 m0, 57344
    s_add_u32 s6, s4, 65536
    buffer_load_dwordx4 v12, s[52:55], s6 offen offset:0 sc1 lds
    buffer_load_dwordx4 v12, s[52:55], s6 offen offset:1024 sc1 lds
    buffer_load_dwordx4 v12, s[52:55], s6 offen offset:2048 sc1 lds
    buffer_load_dwordx4 v12, s[52:55], s6 offen offset:3072 sc1 lds
    s_mov_b32 m0, 61440
    s_add_u32 s6, s4, 98304
    buffer_load_dwordx4 v12, s[52:55], s6 offen offset:0 sc1 lds
    buffer_load_dwordx4 v12, s[52:55], s6 offen offset:1024 sc1 lds
    buffer_load_dwordx4 v12, s[52:55], s6 offen offset:2048 sc1 lds
    buffer_load_dwordx4 v12, s[52:55], s6 offen offset:3072 sc1 lds
    s_add_u32 s11, s11, 4096
    s_and_b32 s11, s11, 0x7fff
    s_add_u32 s4, s12, s11
    s_setprio 3
    s_waitcnt vmcnt(16)
    s_barrier
    s_mov_b32 m0, 98304
    s_add_u32 s6, s4, 0
    buffer_load_dwordx4 v12, s[52:55], s6 offen offset:0 sc1 lds
    buffer_load_dwordx4 v12, s[52:55], s6 offen offset:1024 sc1 lds
    buffer_load_dwordx4 v12, s[52:55], s6 offen offset:2048 sc1 lds
    buffer_load_dwordx4 v12, s[52:55], s6 offen offset:3072 sc1 lds
    s_mov_b32 m0, 102400
    s_add_u32 s6, s4, 32768
    buffer_load_dwordx4 v12, s[52:55], s6 offen offset:0 sc1 lds
    buffer_load_dwordx4 v12, s[52:55], s6 offen offset:1024 sc1 lds
    buffer_load_dwordx4 v12, s[52:55], s6 offen offset:2048 sc1 lds
    buffer_load_dwordx4 v12, s[52:55], s6 offen offset:3072 sc1 lds
    s_mov_b32 m0, 106496
    s_add_u32 s6, s4, 65536
    buffer_load_dwordx4 v12, s[52:55], s6 offen offset:0 sc1 lds
    buffer_load_dwordx4 v12, s[52:55], s6 offen offset:1024 sc1 lds
    buffer_load_dwordx4 v12, s[52:55], s6 offen offset:2048 sc1 lds
    buffer_load_dwordx4 v12, s[52:55], s6 offen offset:3072 sc1 lds
    s_mov_b32 m0, 110592
    s_add_u32 s6, s4, 98304
    buffer_load_dwordx4 v12, s[52:55], s6 offen offset:0 sc1 lds
    buffer_load_dwordx4 v12, s[52:55], s6 offen offset:1024 sc1 lds
    buffer_load_dwordx4 v12, s[52:55], s6 offen offset:2048 sc1 lds
    buffer_load_dwordx4 v12, s[52:55], s6 offen offset:3072 sc1 lds
    s_add_u32 s11, s11, 4096
    s_and_b32 s11, s11, 0x7fff
    s_add_u32 s4, s12, s11
    buffer_load_dwordx2 v[20:21], v14, s[52:55], s19 offen sc1
    s_mov_b64 exec, -1
    s_waitcnt vmcnt(17)
    s_barrier
    s_waitcnt vmcnt(0)
    v_cmp_ne_u64 vcc, s[100:101], v[20:21]
    s_cbranch_vccz POLLF_43
    s_mov_b64 exec, vcc
    s_mov_b32 s95, 0x20000
    s_waitcnt vmcnt(0)
    buffer_load_dwordx2 v[16:17], v14, s[52:55], s19 offen sc1
POLL_44:
    buffer_load_dwordx2 v[18:19], v14, s[52:55], s19 offen sc1
    s_waitcnt vmcnt(1)
    v_cmp_ne_u64 vcc, s[100:101], v[16:17]
    s_nop 0
    s_and_b64 exec, exec, vcc
    s_cbranch_scc0 POLLE_45
    buffer_load_dwordx2 v[16:17], v14, s[52:55], s19 offen sc1
    s_waitcnt vmcnt(1)
    v_cmp_ne_u64 vcc, s[100:101], v[18:19]
    s_nop 0
    s_and_b64 exec, exec, vcc
    s_cbranch_scc0 POLLE_45
    s_sub_u32 s95, s95, 1
    s_cmp_lg_u32 s95, 0
    s_cbranch_scc1 POLL_44
POLLE_45:
    s_mov_b64 exec, -1
POLLF_43:
    s_mov_b32 m0, 32768
    s_add_u32 s6, s4, 0
    buffer_load_dwordx4 v12, s[52:55], s6 offen offset:0 sc1 lds
    buffer_load_dwordx4 v12, s[52:55], s6 offen offset:1024 sc1 lds
    buffer_load_dwordx4 v12, s[52:55], s6 offen offset:2048 sc1 lds
    buffer_load_dwordx4 v12, s[52:55], s6 offen offset:3072 sc1 lds
    s_mov_b32 m0, 36864
    s_add_u32 s6, s4, 32768
    buffer_load_dwordx4 v12, s[52:55], s6 offen offset:0 sc1 lds
    buffer_load_dwordx4 v12, s[52:55], s6 offen offset:1024 sc1 lds
    buffer_load_dwordx4 v12, s[52:55], s6 offen offset:2048 sc1 lds
    buffer_load_dwordx4 v12, s[52:55], s6 offen offset:3072 sc1 lds
    s_mov_b32 m0, 40960
    s_add_u32 s6, s4, 65536
    buffer_load_dwordx4 v12, s[52:55], s6 offen offset:0 sc1 lds
    buffer_load_dwordx4 v12, s[52:55], s6 offen offset:1024 sc1 lds
    buffer_load_dwordx4 v12, s[52:55], s6 offen offset:2048 sc1 lds
    buffer_load_dwordx4 v12, s[52:55], s6 offen offset:3072 sc1 lds
    s_mov_b32 m0, 45056
    s_add_u32 s6, s4, 98304
    buffer_load_dwordx4 v12, s[52:55], s6 offen offset:0 sc1 lds
    buffer_load_dwordx4 v12, s[52:55], s6 offen offset:1024 sc1 lds
    buffer_load_dwordx4 v12, s[52:55], s6 offen offset:2048 sc1 lds
    buffer_load_dwordx4 v12, s[52:55], s6 offen offset:3072 sc1 lds
    s_add_u32 s11, s11, 4096
    s_and_b32 s11, s11, 0x7fff
    s_add_u32 s4, s12, s11
    s_barrier
    s_mov_b32 m0, 49152
    s_add_u32 s6, s4, 0
    buffer_load_dwordx4 v12, s[52:55], s6 offen offset:0 sc1 lds
    buffer_load_dwordx4 v12, s[52:55], s6 offen offset:1024 sc1 lds
    buffer_load_dwordx4 v12, s[52:55], s6 offen offset:2048 sc1 lds
    buffer_load_dwordx4 v12, s[52:55], s6 offen offset:3072 sc1 lds
    s_mov_b32 m0, 53248
    s_add_u32 s6, s4, 32768
    buffer_load_dwordx4 v12, s[52:55], s6 offen offset:0 sc1 lds
    buffer_load_dwordx4 v12, s[52:55], s6 offen offset:1024 sc1 lds
    buffer_load_dwordx4 v12, s[52:55], s6 offen offset:2048 sc1 lds
    buffer_load_dwordx4 v12, s[52:55], s6 offen offset:3072 sc1 lds
    s_mov_b32 m0, 57344
    s_add_u32 s6, s4, 65536
    buffer_load_dwordx4 v12, s[52:55], s6 offen offset:0 sc1 lds
    buffer_load_dwordx4 v12, s[52:55], s6 offen offset:1024 sc1 lds
    buffer_load_dwordx4 v12, s[52:55], s6 offen offset:2048 sc1 lds
    buffer_load_dwordx4 v12, s[52:55], s6 offen offset:3072 sc1 lds
    s_mov_b32 m0, 61440
    s_add_u32 s6, s4, 98304
    buffer_load_dwordx4 v12, s[52:55], s6 offen offset:0 sc1 lds
    buffer_load_dwordx4 v12, s[52:55], s6 offen offset:1024 sc1 lds
    buffer_load_dwordx4 v12, s[52:55], s6 offen offset:2048 sc1 lds
    buffer_load_dwordx4 v12, s[52:55], s6 offen offset:3072 sc1 lds
    s_add_u32 s11, s11, 4096
    s_and_b32 s11, s11, 0x7fff
    s_add_u32 s4, s12, s11
    s_waitcnt vmcnt(16)
    s_barrier
    s_mov_b32 m0, 98304
    s_add_u32 s6, s4, 0
    buffer_load_dwordx4 v12, s[52:55], s6 offen offset:0 sc1 lds
    buffer_load_dwordx4 v12, s[52:55], s6 offen offset:1024 sc1 lds
    buffer_load_dwordx4 v12, s[52:55], s6 offen offset:2048 sc1 lds
    buffer_load_dwordx4 v12, s[52:55], s6 offen offset:3072 sc1 lds
    s_mov_b32 m0, 102400
    s_add_u32 s6, s4, 32768
    buffer_load_dwordx4 v12, s[52:55], s6 offen offset:0 sc1 lds
    buffer_load_dwordx4 v12, s[52:55], s6 offen offset:1024 sc1 lds
    buffer_load_dwordx4 v12, s[52:55], s6 offen offset:2048 sc1 lds
    buffer_load_dwordx4 v12, s[52:55], s6 offen offset:3072 sc1 lds
    s_mov_b32 m0, 106496
    s_add_u32 s6, s4, 65536
    buffer_load_dwordx4 v12, s[52:55], s6 offen offset:0 sc1 lds
    buffer_load_dwordx4 v12, s[52:55], s6 offen offset:1024 sc1 lds
    buffer_load_dwordx4 v12, s[52:55], s6 offen offset:2048 sc1 lds
    buffer_load_dwordx4 v12, s[52:55], s6 offen offset:3072 sc1 lds
    s_mov_b32 m0, 110592
    s_add_u32 s6, s4, 98304
    buffer_load_dwordx4 v12, s[52:55], s6 offen offset:0 sc1 lds
    buffer_load_dwordx4 v12, s[52:55], s6 offen offset:1024 sc1 lds
    buffer_load_dwordx4 v12, s[52:55], s6 offen offset:2048 sc1 lds
    buffer_load_dwordx4 v12, s[52:55], s6 offen offset:3072 sc1 lds
    s_add_u32 s11, s11, 4096
    s_and_b32 s11, s11, 0x7fff
    s_add_u32 s4, s12, s11
    s_waitcnt vmcnt(16)
    s_barrier
    s_mov_b32 m0, 32768
    s_add_u32 s6, s4, 0
    buffer_load_dwordx4 v12, s[52:55], s6 offen offset:0 sc1 lds
    buffer_load_dwordx4 v12, s[52:55], s6 offen offset:1024 sc1 lds
    buffer_load_dwordx4 v12, s[52:55], s6 offen offset:2048 sc1 lds
    buffer_load_dwordx4 v12, s[52:55], s6 offen offset:3072 sc1 lds
    s_mov_b32 m0, 36864
    s_add_u32 s6, s4, 32768
    buffer_load_dwordx4 v12, s[52:55], s6 offen offset:0 sc1 lds
    buffer_load_dwordx4 v12, s[52:55], s6 offen offset:1024 sc1 lds
    buffer_load_dwordx4 v12, s[52:55], s6 offen offset:2048 sc1 lds
    buffer_load_dwordx4 v12, s[52:55], s6 offen offset:3072 sc1 lds
    s_mov_b32 m0, 40960
    s_add_u32 s6, s4, 65536
    buffer_load_dwordx4 v12, s[52:55], s6 offen offset:0 sc1 lds
    buffer_load_dwordx4 v12, s[52:55], s6 offen offset:1024 sc1 lds
    buffer_load_dwordx4 v12, s[52:55], s6 offen offset:2048 sc1 lds
    buffer_load_dwordx4 v12, s[52:55], s6 offen offset:3072 sc1 lds
    s_mov_b32 m0, 45056
    s_add_u32 s6, s4, 98304
    buffer_load_dwordx4 v12, s[52:55], s6 offen offset:0 sc1 lds
    buffer_load_dwordx4 v12, s[52:55], s6 offen offset:1024 sc1 lds
    buffer_load_dwordx4 v12, s[52:55], s6 offen offset:2048 sc1 lds
    buffer_load_dwordx4 v12, s[52:55], s6 offen offset:3072 sc1 lds
    s_add_u32 s11, s11, 4096
    s_and_b32 s11, s11, 0x7fff
    s_add_u32 s4, s12, s11
    s_waitcnt vmcnt(16)
    s_barrier
    s_mov_b32 m0, 49152
    s_add_u32 s6, s4, 0
    buffer_load_dwordx4 v12, s[52:55], s6 offen offset:0 sc1 lds
    buffer_load_dwordx4 v12, s[52:55], s6 offen offset:1024 sc1 lds
    buffer_load_dwordx4 v12, s[52:55], s6 offen offset:2048 sc1 lds
    buffer_load_dwordx4 v12, s[52:55], s6 offen offset:3072 sc1 lds
    s_mov_b32 m0, 53248
    s_add_u32 s6, s4, 32768
    buffer_load_dwordx4 v12, s[52:55], s6 offen offset:0 sc1 lds
    buffer_load_dwordx4 v12, s[52:55], s6 offen offset:1024 sc1 lds
    buffer_load_dwordx4 v12, s[52:55], s6 offen offset:2048 sc1 lds
    buffer_load_dwordx4 v12, s[52:55], s6 offen offset:3072 sc1 lds
    s_mov_b32 m0, 57344
    s_add_u32 s6, s4, 65536
    buffer_load_dwordx4 v12, s[52:55], s6 offen offset:0 sc1 lds
    buffer_load_dwordx4 v12, s[52:55], s6 offen offset:1024 sc1 lds
    buffer_load_dwordx4 v12, s[52:55], s6 offen offset:2048 sc1 lds
    buffer_load_dwordx4 v12, s[52:55], s6 offen offset:3072 sc1 lds
    s_mov_b32 m0, 61440
    s_add_u32 s6, s4, 98304
    buffer_load_dwordx4 v12, s[52:55], s6 offen offset:0 sc1 lds
    buffer_load_dwordx4 v12, s[52:55], s6 offen offset:1024 sc1 lds
    buffer_load_dwordx4 v12, s[52:55], s6 offen offset:2048 sc1 lds
    buffer_load_dwordx4 v12, s[52:55], s6 offen offset:3072 sc1 lds
    s_add_u32 s11, s11, 4096
    s_and_b32 s11, s11, 0x7fff
    s_add_u32 s4, s12, s11
    s_waitcnt vmcnt(16)
    s_barrier
    s_waitcnt vmcnt(0)
    v_lshlrev_b32 v4, 4, v1
    s_sub_u32 s5, s60, 4
    s_bfe_u32 s4, s2, 0x30003
    s_and_b32 s6, s5, 1
    s_lshl1_add_u32 s4, s4, s6
    s_lshr_b32 s6, s5, 1
    s_lshl2_add_u32 s4, s4, s6
    s_mul_i32 s4, s4, 28*1024
    s_add_u32 s4, s4, 20971520
    s_sub_u32 s5, s60, 8
    s_mul_i32 s7, s5, 12288
    s_mul_i32 s8, s5, 10240
    s_barrier
P5_FILL:
    s_lshl_b32 s6, s5, 2
    s_add_u32 s6, s6, 49136
    v_mov_b32 v2, s6
    v_mov_b32 v3, 0
    ds_write_b32 v2, v3
    v_mov_b32 v3, 1
    s_add_u32 m0, s7, 65536
    s_add_u32 s6, s4, 0
    buffer_load_dwordx4 v4, s[52:55], s6 offen offset:0 sc1 lds
    buffer_load_dwordx4 v4, s[52:55], s6 offen offset:1024 sc1 lds
    buffer_load_dwordx4 v4, s[52:55], s6 offen offset:2048 sc1 lds
    buffer_load_dwordx4 v4, s[52:55], s6 offen offset:3072 sc1 lds
    s_add_u32 m0, s7, 69632
    s_add_u32 s6, s4, 4096
    buffer_load_dwordx4 v4, s[52:55], s6 offen offset:0 sc1 lds
    buffer_load_dwordx4 v4, s[52:55], s6 offen offset:1024 sc1 lds
    buffer_load_dwordx4 v4, s[52:55], s6 offen offset:2048 sc1 lds
    buffer_load_dwordx4 v4, s[52:55], s6 offen offset:3072 sc1 lds
    s_add_u32 m0, s7, 73728
    s_add_u32 s6, s4, 8192
    buffer_load_dwordx4 v4, s[52:55], s6 offen offset:0 sc1 lds
    buffer_load_dwordx4 v4, s[52:55], s6 offen offset:1024 sc1 lds
    buffer_load_dwordx4 v4, s[52:55], s6 offen offset:2048 sc1 lds
    buffer_load_dwordx4 v4, s[52:55], s6 offen offset:3072 sc1 lds
    s_add_u32 m0, s8, 118784
    s_add_u32 s6, s4, 12288
    buffer_load_dwordx4 v4, s[52:55], s6 offen offset:0 sc1 lds
    buffer_load_dwordx4 v4, s[52:55], s6 offen offset:1024 sc1 lds
    buffer_load_dwordx4 v4, s[52:55], s6 offen offset:2048 sc1 lds
    buffer_load_dwordx4 v4, s[52:55], s6 offen offset:3072 sc1 lds
    s_add_u32 m0, s8, 122880
    s_add_u32 s6, s4, 16384
    buffer_load_dwordx4 v4, s[52:55], s6 offen offset:0 sc1 lds
    buffer_load_dwordx4 v4, s[52:55], s6 offen offset:1024 sc1 lds
    buffer_load_dwordx4 v4, s[52:55], s6 offen offset:2048 sc1 lds
    buffer_load_dwordx4 v4, s[52:55], s6 offen offset:3072 sc1 lds
    s_add_u32 m0, s8, 126976
    s_add_u32 s6, s4, 20480
    buffer_load_dwordx4 v4, s[52:55], s6 offen offset:0 sc1 lds
    buffer_load_dwordx4 v4, s[52:55], s6 offen offset:1024 sc1 lds
    s_lshl_b32 s16, s26, 7
    s_lshl_b32 s5, s25, 2
    s_add_u32 s16, s16, s5
    s_add_u32 s16, s16, 4096
    s_waitcnt lgkmcnt(0)
    s_lshl_b32 s16, s16, 6
    s_add_u32 s16, s16, 524288
    v_mov_b32 v4, s100
    v_mov_b32 v5, s101
    v_lshlrev_b32 v6, 19, v1
    s_cmp_eq_u32 s60, 8
    s_cselect_b64 exec, 1, 0
    s_barrier
    buffer_store_dwordx2 v[4:5], v6, s[52:55], s16 offen sc1
    s_mov_b64 exec, -1
    s_waitcnt vmcnt(1)
    ds_write_b32 v2, v3
    s_branch P5_END
P5_X:
    s_cmp_eq_u32 s60, 10
    s_cbranch_scc1 P5_X10
    s_barrier
    s_bfe_u32 s25, s2, 0x30003
    s_and_b32 s26, s2, 7
    s_lshl_b32 s26, s26, 2
    s_lshr_b32 s27, s2, 6
    s_add_u32 s26, s26, s27
    s_lshr_b32 s4, s26, 1
    s_lshl_b32 s4, s4, 7
    s_and_b32 s5, s26, 1
    s_lshl_b32 s5, s5, 3
    s_add_u32 s5, s5, s25
    s_lshl_b32 s5, s5, 2
    s_add_u32 s4, s4, s5
    s_add_u32 s4, s4, 4160
    s_lshl_b32 s4, s4, 6
    s_add_u32 s4, s4, 524288
    v_mov_b32 v4, s100
    v_mov_b32 v5, s101
    v_lshlrev_b32 v6, 19, v1
    s_mov_b64 exec, 1
    buffer_store_dwordx2 v[4:5], v6, s[52:55], s4 offen sc1
    s_mov_b64 exec, -1
    s_barrier
    s_barrier
    s_bfe_u32 s4, s2, 0x30003
    s_lshr_b32 s5, s2, 6
    s_lshr_b32 s6, s5, 1
    s_lshl1_add_u32 s4, s4, s6
    s_mul_i32 s4, s4, 112*1024
    s_and_b32 s5, s5, 1
    s_mul_i32 s5, s5, 28*1024
    s_add_u32 s4, s4, s5
    s_add_u32 s4, s4, 21028864
    v_lshlrev_b32 v4, 7, v1
    s_mov_b64 exec, -1
    s_cmp_lt_u32 s2, 248
    s_cbranch_scc1 P5_NORT
    s_mov_b32 s4, 0
    s_getpc_b64 s[8:9]
RTPC_46:
    s_add_u32 s8, s8, P5_END-RTPC_46
    s_addc_u32 s9, s9, 0
    s_lshl_b32 s10, s4, 13
    v_lshl_add_u32 v12, v1, 7, s10
    v_min_u32 v12, CODE_END-P5_END-4, v12
    global_load_dword v13, v12, s[8:9]
P5_NORT:
    s_mov_b32 s61, 4
BAR_47:
    s_barrier
    s_sub_u32 s61, s61, 1
    s_cmp_lg_u32 s61, 0
    s_cbranch_scc1 BAR_47
    s_branch P5_X7
P5_X10:
    v_lshlrev_b32 v12, 4, v1
    s_lshl_b32 s8, s26, 10
    s_add_u32 s8, s8, 65536
    s_setprio 3
    s_lshl_b32 s19, s26, 13
    s_add_u32 s19, s19, 790528
    v_min_u32 v14, 15, v1
    v_lshlrev_b32 v14, 8, v14
    s_barrier
    s_barrier
    s_barrier
    buffer_load_dwordx2 v[20:21], v14, s[52:55], s19 offen sc1
    s_barrier
    s_waitcnt vmcnt(0)
    v_cmp_ne_u64 vcc, s[100:101], v[20:21]
    s_cbranch_vccz POLLF_48
    s_mov_b64 exec, vcc
    s_mov_b32 s95, 0x20000
    s_waitcnt vmcnt(0)
    buffer_load_dwordx2 v[16:17], v14, s[52:55], s19 offen sc1
POLL_49:
    buffer_load_dwordx2 v[18:19], v14, s[52:55], s19 offen sc1
    s_waitcnt vmcnt(1)
    v_cmp_ne_u64 vcc, s[100:101], v[16:17]
    s_nop 0
    s_and_b64 exec, exec, vcc
    s_cbranch_scc0 POLLE_50
    buffer_load_dwordx2 v[16:17], v14, s[52:55], s19 offen sc1
    s_waitcnt vmcnt(1)
    v_cmp_ne_u64 vcc, s[100:101], v[18:19]
    s_nop 0
    s_and_b64 exec, exec, vcc
    s_cbranch_scc0 POLLE_50
    s_sub_u32 s95, s95, 1
    s_cmp_lg_u32 s95, 0
    s_cbranch_scc1 POLL_49
POLLE_50:
    s_mov_b64 exec, -1
POLLF_48:
    s_waitcnt vmcnt(0)
    s_add_u32 s9, s8, 0
    buffer_load_dwordx4 v[24:27], v12, s[52:55], s9 offen sc1
    s_add_u32 s9, s8, 16384
    buffer_load_dwordx4 v[28:31], v12, s[52:55], s9 offen sc1
    s_add_u32 s9, s8, 32768
    buffer_load_dwordx4 v[32:35], v12, s[52:55], s9 offen sc1
    s_add_u32 s9, s8, 49152
    buffer_load_dwordx4 v[36:39], v12, s[52:55], s9 offen sc1
    s_add_u32 s9, s8, 65536
    buffer_load_dwordx4 v[40:43], v12, s[52:55], s9 offen sc1
    s_add_u32 s9, s8, 81920
    buffer_load_dwordx4 v[44:47], v12, s[52:55], s9 offen sc1
    s_add_u32 s9, s8, 98304
    buffer_load_dwordx4 v[48:51], v12, s[52:55], s9 offen sc1
    s_add_u32 s9, s8, 114688
    buffer_load_dwordx4 v[52:55], v12, s[52:55], s9 offen sc1
    s_barrier
    s_waitcnt vmcnt(0)
    v_add_f32 v24, v24, v40
    v_add_f32 v25, v25, v41
    v_add_f32 v26, v26, v42
    v_add_f32 v27, v27, v43
    v_add_f32 v28, v28, v44
    v_add_f32 v29, v29, v45
    v_add_f32 v30, v30, v46
    v_add_f32 v31, v31, v47
    v_add_f32 v32, v32, v48
    v_add_f32 v33, v33, v49
    v_add_f32 v34, v34, v50
    v_add_f32 v35, v35, v51
    v_add_f32 v36, v36, v52
    v_add_f32 v37, v37, v53
    v_add_f32 v38, v38, v54
    v_add_f32 v39, v39, v55
    v_add_f32 v24, v24, v32
    v_add_f32 v25, v25, v33
    v_add_f32 v26, v26, v34
    v_add_f32 v27, v27, v35
    v_add_f32 v28, v28, v36
    v_add_f32 v29, v29, v37
    v_add_f32 v30, v30, v38
    v_add_f32 v31, v31, v39
    v_add_f32 v16, v24, v28
    v_add_f32 v17, v25, v29
    v_add_f32 v18, v26, v30
    v_add_f32 v19, v27, v31
    s_add_u32 s9, s8, 131072
    buffer_load_dwordx4 v[24:27], v12, s[52:55], s9 offen sc1
    s_add_u32 s9, s8, 147456
    buffer_load_dwordx4 v[28:31], v12, s[52:55], s9 offen sc1
    s_add_u32 s9, s8, 163840
    buffer_load_dwordx4 v[32:35], v12, s[52:55], s9 offen sc1
    s_add_u32 s9, s8, 180224
    buffer_load_dwordx4 v[36:39], v12, s[52:55], s9 offen sc1
    s_add_u32 s9, s8, 196608
    buffer_load_dwordx4 v[40:43], v12, s[52:55], s9 offen sc1
    s_add_u32 s9, s8, 212992
    buffer_load_dwordx4 v[44:47], v12, s[52:55], s9 offen sc1
    s_add_u32 s9, s8, 229376
    buffer_load_dwordx4 v[48:51], v12, s[52:55], s9 offen sc1
    s_add_u32 s9, s8, 245760
    buffer_load_dwordx4 v[52:55], v12, s[52:55], s9 offen sc1
    s_barrier
    s_barrier
    s_waitcnt vmcnt(0)
    v_add_f32 v24, v24, v40
    v_add_f32 v25, v25, v41
    v_add_f32 v26, v26, v42
    v_add_f32 v27, v27, v43
    v_add_f32 v28, v28, v44
    v_add_f32 v29, v29, v45
    v_add_f32 v30, v30, v46
    v_add_f32 v31, v31, v47
    v_add_f32 v32, v32, v48
    v_add_f32 v33, v33, v49
    v_add_f32 v34, v34, v50
    v_add_f32 v35, v35, v51
    v_add_f32 v36, v36, v52
    v_add_f32 v37, v37, v53
    v_add_f32 v38, v38, v54
    v_add_f32 v39, v39, v55
    v_add_f32 v24, v24, v32
    v_add_f32 v25, v25, v33
    v_add_f32 v26, v26, v34
    v_add_f32 v27, v27, v35
    v_add_f32 v28, v28, v36
    v_add_f32 v29, v29, v37
    v_add_f32 v30, v30, v38
    v_add_f32 v31, v31, v39
    v_add_f32 v24, v24, v28
    v_add_f32 v25, v25, v29
    v_add_f32 v26, v26, v30
    v_add_f32 v27, v27, v31
    v_add_f32 v24, v24, v16
    v_add_f32 v25, v25, v17
    v_add_f32 v26, v26, v18
    v_add_f32 v27, v27, v19
    v_mul_f32 v28, 0x3b000000, v24
    v_fma_f32 v25, -v24, v28, v25
    v_max_f32 v25, 0, v25
    v_mul_f32 v29, 0x3b000000, v26
    v_fma_f32 v27, -v26, v29, v27
    v_max_f32 v27, 0, v27
    v_mul_f32 v25, 0x3b000000, v25
    v_mul_f32 v27, 0x3b000000, v27
    v_cvt_pk_bf16_f32 v25, v25, v28
    v_cvt_pk_bf16_f32 v27, v27, v29
    v_and_b32 v28, 0xffff0000, v25
    v_lshlrev_b32 v25, 16, v25
    v_and_b32 v29, 0xffff0000, v27
    v_lshlrev_b32 v27, 16, v27
    v_add_f32 v25, 0x3727c5ac, v25
    v_add_f32 v27, 0x3727c5ac, v27
    v_cvt_pk_bf16_f32 v25, v25, v25
    v_lshlrev_b32 v25, 16, v25
    v_cvt_pk_bf16_f32 v27, v27, v27
    v_lshlrev_b32 v27, 16, v27
    v_sqrt_f32 v25, v25
    v_sqrt_f32 v27, v27
    v_cvt_pk_bf16_f32 v25, v25, v25
    v_lshlrev_b32 v25, 16, v25
    v_cvt_pk_bf16_f32 v27, v27, v27
    v_lshlrev_b32 v27, 16, v27
    v_rcp_f32 v32, v25
    v_rcp_f32 v34, v27
    v_mul_f32_e64 v33, -v28, v32
    v_mul_f32_e64 v35, -v29, v34
    v_xor_b32 v28, 0x80000000, v28
    v_cvt_pk_bf16_f32 v40, v28, v28
    v_cvt_pk_bf16_f32 v41, v25, v25
    v_mul_f32 v42, 0xbfb8aa3b, v32
    v_mul_f32 v43, 0xbfb8aa3b, v25
    v_xor_b32 v29, 0x80000000, v29
    v_cvt_pk_bf16_f32 v44, v29, v29
    v_cvt_pk_bf16_f32 v45, v27, v27
    v_mul_f32 v46, 0xbfb8aa3b, v34
    v_mul_f32 v47, 0xbfb8aa3b, v27
    v_lshlrev_b32 v15, 5, v1
    v_add_u32 v15, 114688, v15
    ds_write_b128 v15, v[40:43]
    ds_write_b128 v15, v[44:47] offset:16
    s_setprio 3
P5_X7:
    v_lshlrev_b32 v4, 4, v1
    s_sub_u32 s5, s60, 4
    s_bfe_u32 s4, s2, 0x30003
    s_and_b32 s6, s5, 1
    s_lshl1_add_u32 s4, s4, s6
    s_lshr_b32 s6, s5, 1
    s_lshl2_add_u32 s4, s4, s6
    s_mul_i32 s4, s4, 28*1024
    s_add_u32 s4, s4, 20971520
    s_sub_u32 s5, s60, 8
    s_mul_i32 s7, s5, 12288
    s_mul_i32 s8, s5, 10240
    s_waitcnt lgkmcnt(0)
    s_barrier
    s_branch P5_FILL
P5_LB:
    s_setprio 3
    v_lshlrev_b32 v10, 4, v1
    s_mul_i32 s4, s25, 224*1024
    s_add_u32 s4, s4, 23068672
    s_mov_b32 s5, 131072
    s_mov_b32 s10, 8
P5_LBL:
    s_add_u32 m0, s5, 0
    s_add_u32 s6, s4, 0
    buffer_load_dwordx4 v10, s[52:55], s6 offen offset:0 sc1 lds
    buffer_load_dwordx4 v10, s[52:55], s6 offen offset:1024 sc1 lds
    buffer_load_dwordx4 v10, s[52:55], s6 offen offset:2048 sc1 lds
    buffer_load_dwordx4 v10, s[52:55], s6 offen offset:3072 sc1 lds
    s_add_u32 m0, s5, 4096
    s_add_u32 s6, s4, 4096
    buffer_load_dwordx4 v10, s[52:55], s6 offen offset:0 sc1 lds
    buffer_load_dwordx4 v10, s[52:55], s6 offen offset:1024 sc1 lds
    buffer_load_dwordx4 v10, s[52:55], s6 offen offset:2048 sc1 lds
    buffer_load_dwordx4 v10, s[52:55], s6 offen offset:3072 sc1 lds
    s_add_u32 m0, s5, 8192
    s_add_u32 s6, s4, 8192
    buffer_load_dwordx4 v10, s[52:55], s6 offen offset:0 sc1 lds
    buffer_load_dwordx4 v10, s[52:55], s6 offen offset:1024 sc1 lds
    buffer_load_dwordx4 v10, s[52:55], s6 offen offset:2048 sc1 lds
    buffer_load_dwordx4 v10, s[52:55], s6 offen offset:3072 sc1 lds
    s_add_u32 m0, s5, 12288
    s_add_u32 s6, s4, 12288
    buffer_load_dwordx4 v10, s[52:55], s6 offen offset:0 sc1 lds
    buffer_load_dwordx4 v10, s[52:55], s6 offen offset:1024 sc1 lds
    buffer_load_dwordx4 v10, s[52:55], s6 offen offset:2048 sc1 lds
    buffer_load_dwordx4 v10, s[52:55], s6 offen offset:3072 sc1 lds
    s_add_u32 m0, s5, 16384
    s_add_u32 s6, s4, 16384
    buffer_load_dwordx4 v10, s[52:55], s6 offen offset:0 sc1 lds
    buffer_load_dwordx4 v10, s[52:55], s6 offen offset:1024 sc1 lds
    buffer_load_dwordx4 v10, s[52:55], s6 offen offset:2048 sc1 lds
    buffer_load_dwordx4 v10, s[52:55], s6 offen offset:3072 sc1 lds
    s_add_u32 m0, s5, 20480
    s_add_u32 s6, s4, 20480
    buffer_load_dwordx4 v10, s[52:55], s6 offen offset:0 sc1 lds
    buffer_load_dwordx4 v10, s[52:55], s6 offen offset:1024 sc1 lds
    buffer_load_dwordx4 v10, s[52:55], s6 offen offset:2048 sc1 lds
    buffer_load_dwordx4 v10, s[52:55], s6 offen offset:3072 sc1 lds
    s_add_u32 m0, s5, 24576
    s_add_u32 s6, s4, 24576
    buffer_load_dwordx4 v10, s[52:55], s6 offen offset:0 sc1 lds
    buffer_load_dwordx4 v10, s[52:55], s6 offen offset:1024 sc1 lds
    buffer_load_dwordx4 v10, s[52:55], s6 offen offset:2048 sc1 lds
    buffer_load_dwordx4 v10, s[52:55], s6 offen offset:3072 sc1 lds
    s_add_u32 s4, s4, 28672
    s_add_u32 s5, s5, 65536
    s_cmp_gt_u32 s5, 131072
    s_cselect_b32 s5, 0, s5
    s_sub_u32 s10, s10, 1
    s_cmp_eq_u32 s10, 7
    s_cbranch_scc0 P5_LBE
    s_mov_b32 s61, 4
BAR_51:
    s_barrier
    s_sub_u32 s61, s61, 1
    s_cmp_lg_u32 s61, 0
    s_cbranch_scc1 BAR_51
    s_branch P5_LBL
P5_LBE:
    s_cmp_eq_u32 s10, 6
    s_cbranch_scc0 P5_LBF
    s_barrier
    s_branch P5_LBL
P5_LBF:
    s_cmp_eq_u32 s10, 5
    s_cbranch_scc0 P5_LBN
    s_mul_i32 s6, s25, 896
    s_add_u32 s6, s6, 32768
    s_mov_b32 m0, 116736
    s_add_u32 s7, s6, 14336
    s_waitcnt vmcnt(28)
    buffer_load_dwordx4 v10, s[52:55], s6 offen sc1 lds
    s_mov_b32 m0, 117760
    s_nop 0
    buffer_load_dwordx4 v10, s[52:55], s7 offen sc1 lds
    s_barrier
    s_barrier
    s_branch P5_LBL
P5_LBN:
    s_waitcnt vmcnt(28)
    s_barrier
    s_cmp_lg_u32 s10, 0
    s_cbranch_scc1 P5_LBL
    s_waitcnt vmcnt(0)
    s_branch P5_X7
P5_END:
    s_bfe_u32 s25, s2, 0x30003
    s_and_b32 s26, s2, 7
    s_lshl_b32 s26, s26, 2
    s_lshr_b32 s27, s2, 6
    s_add_u32 s26, s26, s27
    s_cmp_ge_u32 s60, 4
    s_cbranch_scc1 P6_WORK
    s_setprio 0
    v_lshlrev_b32 v5, 4, v1
    s_lshr_b32 s6, s26, 1
    s_lshl_b32 s6, s6, 5
    s_lshl2_add_u32 s6, s60, s6
    s_lshl_b32 s19, s6, 8
    s_add_u32 s19, s19, 786432
    v_lshlrev_b32 v14, 8, v1
    s_mov_b32 s18, 3
    s_mul_i32 s8, s26, 224*1024
    s_mul_i32 s9, s60, 28*1024
    s_add_u32 s8, s8, s9
    s_add_u32 s8, s8, 13631488
    s_lshl_b32 s9, s60, 14
    s_mul_i32 s11, s60, 24576
    s_add_u32 s11, s11, 65536
    v_permlane32_swap_b32 v160, v162
    v_permlane32_swap_b32 v161, v163
    v_permlane32_swap_b32 v164, v166
    v_permlane32_swap_b32 v165, v167
    s_mul_i32 s5, s60, 12288
    s_add_u32 s5, s5, 75776
    v_add_u32 v8, s5, v5
    s_waitcnt vmcnt(0)
    s_setprio 3
    s_barrier
P6_NB:
    s_sleep 4
    s_mov_b32 s95, 0x20000
    s_waitcnt vmcnt(0)
    s_mov_b32 exec_lo, s18
    s_mov_b32 exec_hi, 0
    buffer_load_dwordx2 v[16:17], v14, s[52:55], s19 offen sc1
POLL_52:
    buffer_load_dwordx2 v[18:19], v14, s[52:55], s19 offen sc1
    s_waitcnt vmcnt(1)
    v_cmp_ne_u64 vcc, s[100:101], v[16:17]
    s_nop 0
    s_and_b64 exec, exec, vcc
    s_cbranch_scc0 POLLE_53
    buffer_load_dwordx2 v[16:17], v14, s[52:55], s19 offen sc1
    s_waitcnt vmcnt(1)
    v_cmp_ne_u64 vcc, s[100:101], v[18:19]
    s_nop 0
    s_and_b64 exec, exec, vcc
    s_cbranch_scc0 POLLE_53
    s_sub_u32 s95, s95, 1
    s_cmp_lg_u32 s95, 0
    s_cbranch_scc1 POLL_52
POLLE_53:
    s_mov_b64 exec, -1
    s_add_u32 m0, s9, 0
    s_add_u32 s10, s8, 0
    buffer_load_dwordx4 v5, s[52:55], s10 offen offset:0 sc1 lds
    buffer_load_dwordx4 v5, s[52:55], s10 offen offset:1024 sc1 lds
    s_add_u32 m0, s9, 8192
    s_add_u32 s10, s8, 114688
    buffer_load_dwordx4 v5, s[52:55], s10 offen offset:0 sc1 lds
    buffer_load_dwordx4 v5, s[52:55], s10 offen offset:1024 sc1 lds
    s_add_u32 m0, s9, 2048
    s_add_u32 s10, s8, 2048
    buffer_load_dwordx4 v5, s[52:55], s10 offen offset:0 sc1 lds
    buffer_load_dwordx4 v5, s[52:55], s10 offen offset:1024 sc1 lds
    s_add_u32 m0, s9, 10240
    s_add_u32 s10, s8, 116736
    buffer_load_dwordx4 v5, s[52:55], s10 offen offset:0 sc1 lds
    buffer_load_dwordx4 v5, s[52:55], s10 offen offset:1024 sc1 lds
    s_add_u32 m0, s9, 4096
    s_add_u32 s10, s8, 4096
    buffer_load_dwordx4 v5, s[52:55], s10 offen offset:0 sc1 lds
    buffer_load_dwordx4 v5, s[52:55], s10 offen offset:1024 sc1 lds
    s_add_u32 m0, s9, 12288
    s_add_u32 s10, s8, 118784
    buffer_load_dwordx4 v5, s[52:55], s10 offen offset:0 sc1 lds
    buffer_load_dwordx4 v5, s[52:55], s10 offen offset:1024 sc1 lds
    s_mov_b64 exec, 15
    buffer_load_dwordx2 v[20:21], v14, s[52:55], s19 offen sc1
    s_mov_b64 exec, -1
    s_waitcnt vmcnt(9)
    s_barrier
    ds_write_b128 v8, v[160:163] offset:0
    ds_write_b128 v8, v[164:167] offset:1024
    s_add_u32 m0, s9, 6144
    s_add_u32 s10, s8, 6144
    buffer_load_dwordx4 v5, s[52:55], s10 offen offset:0 sc1 lds
    buffer_load_dwordx4 v5, s[52:55], s10 offen offset:1024 sc1 lds
    s_add_u32 m0, s9, 14336
    s_add_u32 s10, s8, 120832
    buffer_load_dwordx4 v5, s[52:55], s10 offen offset:0 sc1 lds
    buffer_load_dwordx4 v5, s[52:55], s10 offen offset:1024 sc1 lds
    s_waitcnt vmcnt(4)
    v_cmp_ne_u64 vcc, s[100:101], v[20:21]
    s_nop 0
    s_and_b64 vcc, vcc, 15
    s_cbranch_scc0 POLLF_54
    s_mov_b64 exec, vcc
    s_mov_b32 s95, 0x20000
    s_waitcnt vmcnt(0)
    buffer_load_dwordx2 v[16:17], v14, s[52:55], s19 offen sc1
POLL_55:
    buffer_load_dwordx2 v[18:19], v14, s[52:55], s19 offen sc1
    s_waitcnt vmcnt(1)
    v_cmp_ne_u64 vcc, s[100:101], v[16:17]
    s_nop 0
    s_and_b64 exec, exec, vcc
    s_cbranch_scc0 POLLE_56
    buffer_load_dwordx2 v[16:17], v14, s[52:55], s19 offen sc1
    s_waitcnt vmcnt(1)
    v_cmp_ne_u64 vcc, s[100:101], v[18:19]
    s_nop 0
    s_and_b64 exec, exec, vcc
    s_cbranch_scc0 POLLE_56
    s_sub_u32 s95, s95, 1
    s_cmp_lg_u32 s95, 0
    s_cbranch_scc1 POLL_55
POLLE_56:
    s_mov_b64 exec, -1
POLLF_54:
    s_add_u32 m0, s11, 0
    s_add_u32 s10, s8, 8192
    buffer_load_dwordx4 v5, s[52:55], s10 offen offset:0 sc1 lds
    buffer_load_dwordx4 v5, s[52:55], s10 offen offset:1024 sc1 lds
    s_add_u32 m0, s11, 12288
    s_add_u32 s10, s8, 122880
    buffer_load_dwordx4 v5, s[52:55], s10 offen offset:0 sc1 lds
    buffer_load_dwordx4 v5, s[52:55], s10 offen offset:1024 sc1 lds
    s_waitcnt lgkmcnt(0)
    s_barrier
    s_add_u32 m0, s11, 2048
    s_add_u32 s10, s8, 10240
    buffer_load_dwordx4 v5, s[52:55], s10 offen offset:0 sc1 lds
    buffer_load_dwordx4 v5, s[52:55], s10 offen offset:1024 sc1 lds
    s_add_u32 m0, s11, 14336
    s_add_u32 s10, s8, 124928
    buffer_load_dwordx4 v5, s[52:55], s10 offen offset:0 sc1 lds
    buffer_load_dwordx4 v5, s[52:55], s10 offen offset:1024 sc1 lds
    s_barrier
    s_add_u32 m0, s11, 4096
    s_add_u32 s10, s8, 12288
    buffer_load_dwordx4 v5, s[52:55], s10 offen offset:0 sc1 lds
    buffer_load_dwordx4 v5, s[52:55], s10 offen offset:1024 sc1 lds
    s_add_u32 m0, s11, 16384
    s_add_u32 s10, s8, 126976
    buffer_load_dwordx4 v5, s[52:55], s10 offen offset:0 sc1 lds
    buffer_load_dwordx4 v5, s[52:55], s10 offen offset:1024 sc1 lds
    s_waitcnt vmcnt(12)
    s_barrier
    s_add_u32 m0, s11, 6144
    s_add_u32 s10, s8, 14336
    buffer_load_dwordx4 v5, s[52:55], s10 offen offset:0 sc1 lds
    buffer_load_dwordx4 v5, s[52:55], s10 offen offset:1024 sc1 lds
    s_add_u32 m0, s11, 18432
    s_add_u32 s10, s8, 129024
    buffer_load_dwordx4 v5, s[52:55], s10 offen offset:0 sc1 lds
    buffer_load_dwordx4 v5, s[52:55], s10 offen offset:1024 sc1 lds
    s_waitcnt vmcnt(12)
    s_barrier
    s_add_u32 m0, s11, 8192
    s_add_u32 s10, s8, 16384
    buffer_load_dwordx4 v5, s[52:55], s10 offen offset:0 sc1 lds
    buffer_load_dwordx4 v5, s[52:55], s10 offen offset:1024 sc1 lds
    s_add_u32 m0, s11, 20480
    s_add_u32 s10, s8, 131072
    buffer_load_dwordx4 v5, s[52:55], s10 offen offset:0 sc1 lds
    buffer_load_dwordx4 v5, s[52:55], s10 offen offset:1024 sc1 lds
    s_waitcnt vmcnt(12)
    s_barrier
    s_add_u32 m0, s11, 10240
    s_add_u32 s10, s8, 18432
    buffer_load_dwordx4 v5, s[52:55], s10 offen offset:0 sc1 lds
    buffer_load_dwordx4 v5, s[52:55], s10 offen offset:1024 sc1 lds
    s_add_u32 m0, s11, 22528
    s_add_u32 s10, s8, 133120
    buffer_load_dwordx4 v5, s[52:55], s10 offen offset:0 sc1 lds
    buffer_load_dwordx4 v5, s[52:55], s10 offen offset:1024 sc1 lds
    s_waitcnt vmcnt(12)
    s_barrier
    s_add_u32 m0, s9, 0
    s_add_u32 s10, s8, 20480
    buffer_load_dwordx4 v5, s[52:55], s10 offen offset:0 sc1 lds
    buffer_load_dwordx4 v5, s[52:55], s10 offen offset:1024 sc1 lds
    s_add_u32 m0, s9, 8192
    s_add_u32 s10, s8, 135168
    buffer_load_dwordx4 v5, s[52:55], s10 offen offset:0 sc1 lds
    buffer_load_dwordx4 v5, s[52:55], s10 offen offset:1024 sc1 lds
    s_waitcnt vmcnt(12)
    s_barrier
    s_add_u32 m0, s9, 2048
    s_add_u32 s10, s8, 22528
    buffer_load_dwordx4 v5, s[52:55], s10 offen offset:0 sc1 lds
    buffer_load_dwordx4 v5, s[52:55], s10 offen offset:1024 sc1 lds
    s_add_u32 m0, s9, 10240
    s_add_u32 s10, s8, 137216
    buffer_load_dwordx4 v5, s[52:55], s10 offen offset:0 sc1 lds
    buffer_load_dwordx4 v5, s[52:55], s10 offen offset:1024 sc1 lds
    s_waitcnt vmcnt(12)
    s_barrier
    s_add_u32 m0, s9, 4096
    s_add_u32 s10, s8, 24576
    buffer_load_dwordx4 v5, s[52:55], s10 offen offset:0 sc1 lds
    buffer_load_dwordx4 v5, s[52:55], s10 offen offset:1024 sc1 lds
    buffer_load_dwordx4 v5, s[52:55], s10 offen offset:2048 sc1 lds
    buffer_load_dwordx4 v5, s[52:55], s10 offen offset:3072 sc1 lds
    s_waitcnt vmcnt(12)
    s_barrier
    s_add_u32 m0, s9, 12288
    s_add_u32 s10, s8, 139264
    buffer_load_dwordx4 v5, s[52:55], s10 offen offset:0 sc1 lds
    buffer_load_dwordx4 v5, s[52:55], s10 offen offset:1024 sc1 lds
    s_waitcnt vmcnt(10)
    s_barrier
    s_add_u32 m0, s9, 14336
    s_add_u32 s10, s8, 141312
    buffer_load_dwordx4 v5, s[52:55], s10 offen offset:0 sc1 lds
    buffer_load_dwordx4 v5, s[52:55], s10 offen offset:1024 sc1 lds
    s_waitcnt vmcnt(8)
    s_barrier
    s_waitcnt vmcnt(4)
    s_barrier
    s_waitcnt vmcnt(2)
    s_barrier
    s_waitcnt vmcnt(0)
    s_barrier
    s_endpgm
P6_WORK:
    s_setprio 1
    s_bfe_u32 s4, s60, 0x20001
    s_lshl_b32 s5, s4, 14
    s_mul_i32 s4, s4, 24576
    s_add_u32 s4, s4, 65536
    v_and_b32 v3, 48, v1
    v_add_u32 v3, v3, v1
    v_lshlrev_b32 v3, 4, v3
    v_add_u32 v2, s5, v3
    v_add_u32 v3, s4, v3
    s_and_b32 s4, s60, 1
    s_mul_i32 s4, s4, 12288
    v_add_u32 v7, s4, v3
    v_and_b32 v4, 32, v1
    v_lshl_add_u32 v7, v4, 1, v7
    s_and_b32 s5, s60, 3
    s_bfe_u32 s6, s60, 0x10002
    v_lshrrev_b32 v4, 3, v1
    v_lshl_add_u32 v4, s5, 3, v4
    v_bfe_u32 v5, v1, 2, 1
    v_mul_u32_u24 v5, 12288, v5
    v_and_b32 v0, 3, v1
    v_mul_u32_u24 v6, 1088, v0
    v_lshl_add_u32 v6, v4, 4, v6
    v_add_u32 v6, v5, v6
    s_mul_i32 s7, s6, 4352
    s_add_u32 s7, s7, 65536
    v_add_u32 v6, s7, v6
    v_lshlrev_b32 v0, 9, v0
    v_lshl_add_u32 v0, v4, 4, v0
    v_lshl_add_u32 v0, v5, 1, v0
    s_mul_i32 s7, s6, 12288
    s_add_u32 s7, s7, 75776
    v_add_u32 v0, s7, v0
    v_and_b32 v5, 7, v1
    v_lshlrev_b32 v4, 10, v4
    v_lshl_add_u32 v4, v5, 4, v4
    v_lshlrev_b32 v5, 5, v5
    s_lshl_b32 s4, s26, 16
    s_lshl_b32 s6, s6, 15
    s_add_u32 s4, s4, s6
    s_lshl_b32 s6, s25, 7
    s_add_u32 s4, s4, s6
    s_lshl_b32 s7, s25, 8
    s_add_u32 s7, s7, 10240
    s_waitcnt vmcnt(0) lgkmcnt(0)
    s_barrier
    ds_read_b128 v[8:11], v2 offset:0
    ds_read_b128 v[12:15], v2 offset:8192
    ds_read_b128 v[16:19], v2 offset:256
    ds_read_b128 v[20:23], v2 offset:8448
    s_waitcnt lgkmcnt(3)
    v_mfma_f32_16x16x32_bf16 v[24:27], v[56:59], v[8:11], 0
    v_mfma_f32_16x16x32_bf16 v[32:35], v[60:63], v[8:11], 0
    s_waitcnt lgkmcnt(2)
    v_mfma_f32_16x16x32_bf16 v[40:43], v[56:59], v[12:15], 0
    v_mfma_f32_16x16x32_bf16 v[48:51], v[60:63], v[12:15], 0
    s_waitcnt lgkmcnt(1)
    v_mfma_f32_16x16x32_bf16 v[28:31], v[56:59], v[16:19], 0
    v_mfma_f32_16x16x32_bf16 v[36:39], v[60:63], v[16:19], 0
    s_barrier
    ds_read_b128 v[8:11], v2 offset:2048
    ds_read_b128 v[12:15], v2 offset:10240
    s_waitcnt lgkmcnt(2)
    v_mfma_f32_16x16x32_bf16 v[44:47], v[56:59], v[20:23], 0
    v_mfma_f32_16x16x32_bf16 v[52:55], v[60:63], v[20:23], 0
    ds_read_b128 v[16:19], v2 offset:2304
    s_waitcnt lgkmcnt(2)
    v_mfma_f32_16x16x32_bf16 v[24:27], v[64:67], v[8:11], v[24:27]
    v_mfma_f32_16x16x32_bf16 v[32:35], v[68:71], v[8:11], v[32:35]
    ds_read_b128 v[20:23], v2 offset:10496
    s_waitcnt lgkmcnt(2)
    v_mfma_f32_16x16x32_bf16 v[40:43], v[64:67], v[12:15], v[40:43]
    v_mfma_f32_16x16x32_bf16 v[48:51], v[68:71], v[12:15], v[48:51]
    s_waitcnt lgkmcnt(1)
    v_mfma_f32_16x16x32_bf16 v[28:31], v[64:67], v[16:19], v[28:31]
    v_mfma_f32_16x16x32_bf16 v[36:39], v[68:71], v[16:19], v[36:39]
    s_barrier
    ds_read_b128 v[56:59], v2 offset:4096
    ds_read_b128 v[60:63], v2 offset:12288
    s_waitcnt lgkmcnt(2)
    v_mfma_f32_16x16x32_bf16 v[44:47], v[64:67], v[20:23], v[44:47]
    v_mfma_f32_16x16x32_bf16 v[52:55], v[68:71], v[20:23], v[52:55]
    ds_read_b128 v[8:11], v2 offset:4352
    s_waitcnt lgkmcnt(2)
    v_mfma_f32_16x16x32_bf16 v[24:27], v[72:75], v[56:59], v[24:27]
    v_mfma_f32_16x16x32_bf16 v[32:35], v[76:79], v[56:59], v[32:35]
    ds_read_b128 v[12:15], v2 offset:12544
    s_waitcnt lgkmcnt(2)
    v_mfma_f32_16x16x32_bf16 v[40:43], v[72:75], v[60:63], v[40:43]
    v_mfma_f32_16x16x32_bf16 v[48:51], v[76:79], v[60:63], v[48:51]
    s_waitcnt lgkmcnt(1)
    v_mfma_f32_16x16x32_bf16 v[28:31], v[72:75], v[8:11], v[28:31]
    v_mfma_f32_16x16x32_bf16 v[36:39], v[76:79], v[8:11], v[36:39]
    s_barrier
    ds_read_b128 v[64:67], v0
    ds_read_b128 v[16:19], v2 offset:6144
    ds_read_b128 v[20:23], v2 offset:14336
    s_waitcnt lgkmcnt(3)
    v_mfma_f32_16x16x32_bf16 v[44:47], v[72:75], v[12:15], v[44:47]
    v_mfma_f32_16x16x32_bf16 v[52:55], v[76:79], v[12:15], v[52:55]
    ds_read_b128 v[56:59], v2 offset:6400
    s_waitcnt lgkmcnt(2)
    v_mfma_f32_16x16x32_bf16 v[24:27], v[80:83], v[16:19], v[24:27]
    v_mfma_f32_16x16x32_bf16 v[32:35], v[84:87], v[16:19], v[32:35]
    ds_read_b128 v[60:63], v2 offset:14592
    s_waitcnt lgkmcnt(2)
    v_mfma_f32_16x16x32_bf16 v[40:43], v[80:83], v[20:23], v[40:43]
    v_mfma_f32_16x16x32_bf16 v[48:51], v[84:87], v[20:23], v[48:51]
    s_waitcnt lgkmcnt(1)
    v_mfma_f32_16x16x32_bf16 v[28:31], v[80:83], v[56:59], v[28:31]
    v_mfma_f32_16x16x32_bf16 v[36:39], v[84:87], v[56:59], v[36:39]
    s_barrier
    ds_read_b128 v[8:11], v3 offset:0
    ds_read_b128 v[12:15], v3 offset:12288
    s_waitcnt lgkmcnt(2)
    v_mfma_f32_16x16x32_bf16 v[44:47], v[80:83], v[60:63], v[44:47]
    v_mfma_f32_16x16x32_bf16 v[52:55], v[84:87], v[60:63], v[52:55]
    ds_read_b128 v[16:19], v3 offset:256
    s_waitcnt lgkmcnt(2)
    v_mfma_f32_16x16x32_bf16 v[24:27], v[88:91], v[8:11], v[24:27]
    v_mfma_f32_16x16x32_bf16 v[32:35], v[92:95], v[8:11], v[32:35]
    ds_read_b128 v[20:23], v3 offset:12544
    s_waitcnt lgkmcnt(2)
    v_mfma_f32_16x16x32_bf16 v[40:43], v[88:91], v[12:15], v[40:43]
    v_mfma_f32_16x16x32_bf16 v[48:51], v[92:95], v[12:15], v[48:51]
    s_waitcnt lgkmcnt(1)
    v_mfma_f32_16x16x32_bf16 v[28:31], v[88:91], v[16:19], v[28:31]
    v_mfma_f32_16x16x32_bf16 v[36:39], v[92:95], v[16:19], v[36:39]
    s_barrier
    buffer_load_dwordx4 v[72:75], v5, s[52:55], s7 offen offset:0 sc1
    buffer_load_dwordx4 v[76:79], v5, s[52:55], s7 offen offset:16 sc1
    v_add_u32 v5, 49152, v6
    ds_read_b128 v[56:59], v3 offset:2048
    ds_read_b128 v[60:63], v3 offset:14336
    s_waitcnt lgkmcnt(2)
    v_mfma_f32_16x16x32_bf16 v[44:47], v[88:91], v[20:23], v[44:47]
    v_mfma_f32_16x16x32_bf16 v[52:55], v[92:95], v[20:23], v[52:55]
    ds_read_b128 v[8:11], v3 offset:2304
    s_waitcnt lgkmcnt(2)
    v_mfma_f32_16x16x32_bf16 v[24:27], v[96:99], v[56:59], v[24:27]
    v_mfma_f32_16x16x32_bf16 v[32:35], v[100:103], v[56:59], v[32:35]
    ds_read_b128 v[12:15], v3 offset:14592
    s_waitcnt lgkmcnt(2)
    v_mfma_f32_16x16x32_bf16 v[40:43], v[96:99], v[60:63], v[40:43]
    v_mfma_f32_16x16x32_bf16 v[48:51], v[100:103], v[60:63], v[48:51]
    s_waitcnt lgkmcnt(1)
    v_mfma_f32_16x16x32_bf16 v[28:31], v[96:99], v[8:11], v[28:31]
    v_mfma_f32_16x16x32_bf16 v[36:39], v[100:103], v[8:11], v[36:39]
    s_barrier
    ds_read_b128 v[16:19], v3 offset:4096
    ds_read_b128 v[20:23], v3 offset:16384
    s_waitcnt lgkmcnt(2)
    v_mfma_f32_16x16x32_bf16 v[44:47], v[96:99], v[12:15], v[44:47]
    v_mfma_f32_16x16x32_bf16 v[52:55], v[100:103], v[12:15], v[52:55]
    ds_read_b128 v[56:59], v3 offset:4352
    s_waitcnt lgkmcnt(2)
    v_mfma_f32_16x16x32_bf16 v[24:27], v[104:107], v[16:19], v[24:27]
    v_mfma_f32_16x16x32_bf16 v[32:35], v[108:111], v[16:19], v[32:35]
    ds_read_b128 v[60:63], v3 offset:16640
    s_waitcnt lgkmcnt(2)
    v_mfma_f32_16x16x32_bf16 v[40:43], v[104:107], v[20:23], v[40:43]
    v_mfma_f32_16x16x32_bf16 v[48:51], v[108:111], v[20:23], v[48:51]
    s_waitcnt lgkmcnt(1)
    v_mfma_f32_16x16x32_bf16 v[28:31], v[104:107], v[56:59], v[28:31]
    v_mfma_f32_16x16x32_bf16 v[36:39], v[108:111], v[56:59], v[36:39]
    s_barrier
    v_lshlrev_b32 v80, 16, v64
    v_and_b32 v81, 0xffff0000, v64
    v_lshlrev_b32 v82, 16, v65
    v_and_b32 v83, 0xffff0000, v65
    v_lshlrev_b32 v84, 16, v66
    v_and_b32 v85, 0xffff0000, v66
    v_lshlrev_b32 v86, 16, v67
    v_and_b32 v87, 0xffff0000, v67
    ds_read_b128 v[8:11], v3 offset:6144
    ds_read_b128 v[12:15], v3 offset:18432
    s_waitcnt lgkmcnt(2)
    v_mfma_f32_16x16x32_bf16 v[44:47], v[104:107], v[60:63], v[44:47]
    v_mfma_f32_16x16x32_bf16 v[52:55], v[108:111], v[60:63], v[52:55]
    ds_read_b128 v[16:19], v3 offset:6400
    s_waitcnt lgkmcnt(2)
    v_mfma_f32_16x16x32_bf16 v[24:27], v[112:115], v[8:11], v[24:27]
    v_mfma_f32_16x16x32_bf16 v[32:35], v[116:119], v[8:11], v[32:35]
    ds_read_b128 v[20:23], v3 offset:18688
    s_waitcnt lgkmcnt(2)
    v_mfma_f32_16x16x32_bf16 v[40:43], v[112:115], v[12:15], v[40:43]
    v_mfma_f32_16x16x32_bf16 v[48:51], v[116:119], v[12:15], v[48:51]
    s_waitcnt lgkmcnt(1)
    v_mfma_f32_16x16x32_bf16 v[28:31], v[112:115], v[16:19], v[28:31]
    v_mfma_f32_16x16x32_bf16 v[36:39], v[116:119], v[16:19], v[36:39]
    s_barrier
    ds_read_b128 v[56:59], v3 offset:8192
    ds_read_b128 v[60:63], v3 offset:20480
    s_waitcnt lgkmcnt(2)
    v_mfma_f32_16x16x32_bf16 v[44:47], v[112:115], v[20:23], v[44:47]
    v_mfma_f32_16x16x32_bf16 v[52:55], v[116:119], v[20:23], v[52:55]
    ds_read_b128 v[8:11], v3 offset:8448
    s_waitcnt lgkmcnt(2)
    v_mfma_f32_16x16x32_bf16 v[24:27], v[120:123], v[56:59], v[24:27]
    v_mfma_f32_16x16x32_bf16 v[32:35], v[124:127], v[56:59], v[32:35]
    ds_read_b128 v[12:15], v3 offset:20736
    s_waitcnt lgkmcnt(2)
    v_mfma_f32_16x16x32_bf16 v[40:43], v[120:123], v[60:63], v[40:43]
    v_mfma_f32_16x16x32_bf16 v[48:51], v[124:127], v[60:63], v[48:51]
    s_waitcnt lgkmcnt(1)
    v_mfma_f32_16x16x32_bf16 v[28:31], v[120:123], v[8:11], v[28:31]
    v_mfma_f32_16x16x32_bf16 v[36:39], v[124:127], v[8:11], v[36:39]
    s_barrier
    ds_read_b128 v[16:19], v3 offset:10240
    ds_read_b128 v[20:23], v3 offset:22528
    s_waitcnt lgkmcnt(2)
    v_mfma_f32_16x16x32_bf16 v[44:47], v[120:123], v[12:15], v[44:47]
    v_mfma_f32_16x16x32_bf16 v[52:55], v[124:127], v[12:15], v[52:55]
    ds_read_b128 v[56:59], v3 offset:10496
    s_waitcnt lgkmcnt(2)
    v_mfma_f32_16x16x32_bf16 v[24:27], v[128:131], v[16:19], v[24:27]
    v_mfma_f32_16x16x32_bf16 v[32:35], v[132:135], v[16:19], v[32:35]
    ds_read_b128 v[60:63], v3 offset:22784
    s_waitcnt lgkmcnt(2)
    v_mfma_f32_16x16x32_bf16 v[40:43], v[128:131], v[20:23], v[40:43]
    v_mfma_f32_16x16x32_bf16 v[48:51], v[132:135], v[20:23], v[48:51]
    s_waitcnt lgkmcnt(1)
    v_mfma_f32_16x16x32_bf16 v[28:31], v[128:131], v[56:59], v[28:31]
    v_mfma_f32_16x16x32_bf16 v[36:39], v[132:135], v[56:59], v[36:39]
    s_barrier
    ds_read_b128 v[8:11], v2 offset:0
    ds_read_b128 v[12:15], v2 offset:8192
    s_waitcnt lgkmcnt(2)
    v_mfma_f32_16x16x32_bf16 v[44:47], v[128:131], v[60:63], v[44:47]
    v_mfma_f32_16x16x32_bf16 v[52:55], v[132:135], v[60:63], v[52:55]
    ds_read_b128 v[16:19], v2 offset:256
    s_waitcnt lgkmcnt(2)
    v_mfma_f32_16x16x32_bf16 v[24:27], v[136:139], v[8:11], v[24:27]
    v_mfma_f32_16x16x32_bf16 v[32:35], v[140:143], v[8:11], v[32:35]
    ds_read_b128 v[20:23], v2 offset:8448
    s_waitcnt lgkmcnt(2)
    v_mfma_f32_16x16x32_bf16 v[40:43], v[136:139], v[12:15], v[40:43]
    v_mfma_f32_16x16x32_bf16 v[48:51], v[140:143], v[12:15], v[48:51]
    s_waitcnt lgkmcnt(1)
    v_mfma_f32_16x16x32_bf16 v[28:31], v[136:139], v[16:19], v[28:31]
    v_mfma_f32_16x16x32_bf16 v[36:39], v[140:143], v[16:19], v[36:39]
    s_barrier
    ds_read_b128 v[56:59], v2 offset:2048
    ds_read_b128 v[60:63], v2 offset:10240
    s_waitcnt lgkmcnt(2)
    v_mfma_f32_16x16x32_bf16 v[44:47], v[136:139], v[20:23], v[44:47]
    v_mfma_f32_16x16x32_bf16 v[52:55], v[140:143], v[20:23], v[52:55]
    ds_read_b128 v[8:11], v2 offset:2304
    s_waitcnt lgkmcnt(2)
    v_mfma_f32_16x16x32_bf16 v[24:27], v[144:147], v[56:59], v[24:27]
    v_mfma_f32_16x16x32_bf16 v[32:35], v[148:151], v[56:59], v[32:35]
    ds_read_b128 v[12:15], v2 offset:10496
    s_waitcnt lgkmcnt(2)
    v_mfma_f32_16x16x32_bf16 v[40:43], v[144:147], v[60:63], v[40:43]
    v_mfma_f32_16x16x32_bf16 v[48:51], v[148:151], v[60:63], v[48:51]
    s_waitcnt lgkmcnt(1)
    v_mfma_f32_16x16x32_bf16 v[28:31], v[144:147], v[8:11], v[28:31]
    v_mfma_f32_16x16x32_bf16 v[36:39], v[148:151], v[8:11], v[36:39]
    s_barrier
    ds_read_b128 v[16:19], v2 offset:4096
    ds_read_b128 v[20:23], v2 offset:4352
    s_waitcnt lgkmcnt(2)
    v_mfma_f32_16x16x32_bf16 v[44:47], v[144:147], v[12:15], v[44:47]
    v_mfma_f32_16x16x32_bf16 v[52:55], v[148:151], v[12:15], v[52:55]
    ds_read_b128 v[56:59], v2 offset:6144
    s_waitcnt lgkmcnt(2)
    v_mfma_f32_16x16x32_bf16 v[24:27], v[152:155], v[16:19], v[24:27]
    v_mfma_f32_16x16x32_bf16 v[32:35], v[156:159], v[16:19], v[32:35]
    ds_read_b128 v[60:63], v2 offset:6400
    s_waitcnt lgkmcnt(2)
    v_mfma_f32_16x16x32_bf16 v[28:31], v[152:155], v[20:23], v[28:31]
    v_mfma_f32_16x16x32_bf16 v[36:39], v[156:159], v[20:23], v[36:39]
    s_waitcnt lgkmcnt(1)
    v_mfma_f32_16x16x32_bf16 v[24:27], v[160:163], v[56:59], v[24:27]
    v_mfma_f32_16x16x32_bf16 v[32:35], v[164:167], v[56:59], v[32:35]
    s_barrier
    ds_read_b128 v[8:11], v2 offset:12288
    ds_read_b128 v[12:15], v2 offset:12544
    s_waitcnt lgkmcnt(2)
    v_mfma_f32_16x16x32_bf16 v[28:31], v[160:163], v[60:63], v[28:31]
    v_mfma_f32_16x16x32_bf16 v[36:39], v[164:167], v[60:63], v[36:39]
    s_waitcnt lgkmcnt(1)
    v_mfma_f32_16x16x32_bf16 v[40:43], v[152:155], v[8:11], v[40:43]
    v_mfma_f32_16x16x32_bf16 v[48:51], v[156:159], v[8:11], v[48:51]
    s_barrier
    ds_read_b128 v[16:19], v2 offset:14336
    ds_read_b128 v[20:23], v2 offset:14592
    ds_write_b128 v7, v[24:27] offset:0
    ds_write_b128 v7, v[28:31] offset:256
    s_waitcnt lgkmcnt(4)
    v_mfma_f32_16x16x32_bf16 v[44:47], v[152:155], v[12:15], v[44:47]
    v_mfma_f32_16x16x32_bf16 v[52:55], v[156:159], v[12:15], v[52:55]
    ds_write_b128 v7, v[32:35] offset:2176
    ds_write_b128 v7, v[36:39] offset:2432
    s_waitcnt lgkmcnt(5)
    v_mfma_f32_16x16x32_bf16 v[40:43], v[160:163], v[16:19], v[40:43]
    v_mfma_f32_16x16x32_bf16 v[48:51], v[164:167], v[16:19], v[48:51]
    s_waitcnt lgkmcnt(4)
    v_mfma_f32_16x16x32_bf16 v[44:47], v[160:163], v[20:23], v[44:47]
    v_mfma_f32_16x16x32_bf16 v[52:55], v[164:167], v[20:23], v[52:55]
    s_nop 3
    ds_write_b128 v7, v[40:43] offset:4352
    s_nop 1
    ds_write_b128 v7, v[44:47] offset:4608
    ds_write_b128 v7, v[48:51] offset:6528
    ds_write_b128 v7, v[52:55] offset:6784
    s_waitcnt vmcnt(0) lgkmcnt(0)
    s_barrier
    ds_read_b128 v[88:91], v6 offset:0
    ds_read_b128 v[92:95], v6 offset:512
    ds_read_b128 v[96:99], v6 offset:24576
    ds_read_b128 v[100:103], v6 offset:25088
    ds_read_b128 v[104:107], v5 offset:0
    ds_read_b128 v[108:111], v5 offset:512
    ds_read_b128 v[112:115], v5 offset:24576
    ds_read_b128 v[116:119], v5 offset:25088
    s_waitcnt lgkmcnt(4)
    v_pk_add_f32 v[88:89], v[88:89], v[96:97]
    v_pk_add_f32 v[90:91], v[90:91], v[98:99]
    v_pk_add_f32 v[92:93], v[92:93], v[100:101]
    v_pk_add_f32 v[94:95], v[94:95], v[102:103]
    s_waitcnt lgkmcnt(0)
    v_pk_add_f32 v[104:105], v[104:105], v[112:113]
    v_pk_add_f32 v[106:107], v[106:107], v[114:115]
    v_pk_add_f32 v[108:109], v[108:109], v[116:117]
    v_pk_add_f32 v[110:111], v[110:111], v[118:119]
    v_pk_add_f32 v[88:89], v[88:89], v[104:105]
    v_pk_add_f32 v[90:91], v[90:91], v[106:107]
    v_pk_add_f32 v[92:93], v[92:93], v[108:109]
    v_pk_add_f32 v[94:95], v[94:95], v[110:111]
    v_pk_fma_f32 v[80:81], v[72:73], v[88:89], v[80:81]
    v_pk_fma_f32 v[82:83], v[74:75], v[90:91], v[82:83]
    v_pk_fma_f32 v[84:85], v[76:77], v[92:93], v[84:85]
    v_pk_fma_f32 v[86:87], v[78:79], v[94:95], v[86:87]
    v_cvt_pk_bf16_f32 v8, v80, v81
    v_cvt_pk_bf16_f32 v9, v82, v83
    v_cvt_pk_bf16_f32 v10, v84, v85
    v_cvt_pk_bf16_f32 v11, v86, v87
    buffer_store_dwordx4 v[8:11], v4, s[56:59], s4 offen sc1
    s_endpgm
KB_EXIT:
    s_endpgm

CODE_END:
    s_endpgm
.section .rodata,"a"
.p2align 6
.amdhsa_kernel adaLN_cond__softmax_full_mha__swiglu_ffn__prompt_kernel
  .amdhsa_next_free_vgpr 168
  .amdhsa_next_free_sgpr 102
  .amdhsa_accum_offset 168
  .amdhsa_group_segment_fixed_size 0
  .amdhsa_kernarg_size 96
  .amdhsa_user_sgpr_count 2
  .amdhsa_user_sgpr_kernarg_segment_ptr 1
  .amdhsa_system_sgpr_workgroup_id_x 1
.end_amdhsa_kernel
```
